```python
import torch

def _softmax(x, axis=-1):
    return torch.softmax(x, dim=axis)
def _gelu(x):
    return torch.nn.functional.gelu(x, approximate="tanh")
def _silu(x):
    return torch.nn.functional.silu(x)
def _sigmoid(x):
    return torch.sigmoid(x)
def _layernorm(x, axis=-1, eps=1e-5):
    m = x.mean(dim=axis, keepdim=True)
    v = x.var(dim=axis, keepdim=True, unbiased=False)
    return (x - m) / torch.sqrt(v + eps)
def _scatter_add(tgt, idx, src, axis=0):
    return tgt.clone().index_add_(axis, idx, src)
def _segment_sum(src, seg, n):
    out = torch.zeros((n,) + src.shape[1:], dtype=src.dtype)
    return out.index_add_(0, seg, src)
def _pad(x, pw):
    flat = tuple(v for pair in reversed(pw) for v in pair)
    return torch.nn.functional.pad(x, flat)

kernel_name = 'sequential_preLN__grouped_kv_mqa__moe_arch_mod__prompt'

def setup_inputs():

    _w = (lambda a: (lambda t: t.to(torch.bfloat16) if t.is_floating_point() else t)(torch.as_tensor(a)))
    def _A_setup():
        B, S, D, H = 1, 2048, 576, 32
        Dh = D // H
        return {
            "x": _w((lambda *s: torch.randn(*s, dtype=torch.bfloat16) * 0.05)(B, S, D)),
            "wq": _w((lambda *s: torch.randn(*s, dtype=torch.bfloat16) * 0.05)(D, H * Dh)),
            "wk": _w((lambda *s: torch.randn(*s, dtype=torch.bfloat16) * 0.05)(D, Dh)),
            "wv": _w((lambda *s: torch.randn(*s, dtype=torch.bfloat16) * 0.05)(D, Dh)),
            "wo": _w((lambda *s: torch.randn(*s, dtype=torch.bfloat16) * 0.05)(H * Dh, D)),
        }
    _A_in = _A_setup()

    def _B_setup():
        B, S, D, F, C = 1, 2048, 576, 4608, 1
        return {
            "x": _w((lambda *s: torch.randn(*s, dtype=torch.bfloat16) * 0.05)(B, S, D)),
            "w_r": _w((lambda *s: torch.randn(*s, dtype=torch.bfloat16) * 0.05)(D)),
            "w_gate": _w((lambda *s: torch.randn(*s, dtype=torch.bfloat16) * 0.05)(D, F)),
            "w_up": _w((lambda *s: torch.randn(*s, dtype=torch.bfloat16) * 0.05)(D, F)),
            "w_down": _w((lambda *s: torch.randn(*s, dtype=torch.bfloat16) * 0.05)(F, D)),
        }
    _B_in = _B_setup()

    return {
        "A_x": _A_in["x"],
        "A_wq": _A_in["wq"],
        "A_wk": _A_in["wk"],
        "A_wv": _A_in["wv"],
        "A_wo": _A_in["wo"],
        "B_x": _B_in["x"],
        "B_w_r": _B_in["w_r"],
        "B_w_gate": _B_in["w_gate"],
        "B_w_up": _B_in["w_up"],
        "B_w_down": _B_in["w_down"],
    }

def reference(A_x, A_wq, A_wk, A_wv, A_wo, B_x, B_w_r, B_w_gate, B_w_up, B_w_down):
    def _A_ref(x, wq, wk, wv, wo):
        B, S, D = x.shape
        H = 32
        Dh = D // H
        q = (lambda x, *d: x.permute(*d))((x @ wq).reshape(B, S, H, Dh), 0, 2, 1, 3)
        k = x @ wk
        v = x @ wv
        scores = torch.einsum("bhqd,bkd->bhqk", q, k) * (Dh ** -0.5)
        p = _softmax(scores, axis=-1)
        o = torch.einsum("bhqk,bkd->bhqd", p, v)
        return (lambda x, *d: x.permute(*d))(o, 0, 2, 1, 3).reshape(B, S, H * Dh) @ wo

    def _B_ref(x, w_r, w_gate, w_up, w_down):
        B, S, D = x.shape
        C = 1
        r = x @ w_r
        idx = torch.argsort(-r, axis=-1)[:, :C]
        idx_e = (lambda x, n, axis: torch.repeat_interleave(x, n, dim=axis))(idx.reshape(B, C, 1), D, axis=2)
        x_sel = (lambda x, i, axis: torch.take_along_dim(x, i, dim=axis))(x, idx_e, axis=1)
        g = _silu(x_sel @ w_gate)
        u = x_sel @ w_up
        y = (g * u) @ w_down
        r_sel = _sigmoid((lambda x, i, axis: torch.take_along_dim(x, i, dim=axis))(r, idx, axis=1))
        y = y * r_sel.reshape(B, C, 1)
        b_off = (torch.arange(B) * S).reshape(B, 1)
        flat_idx = (idx + b_off).reshape(B * C)
        zero = (x * 0.0).reshape(B * S, D)
        upd = _scatter_add(zero, flat_idx, y.reshape(B * C, D), axis=0)
        return x + upd.reshape(B, S, D)

    x = A_x
    h = x + _A_ref(_layernorm(x, axis=-1), A_wq, A_wk, A_wv, A_wo)
    h2 = h + _B_ref(_layernorm(h, axis=-1), B_w_r, B_w_gate, B_w_up, B_w_down)
    return h2
```

```asm
; @launch grid=(256,1,1) block=(512,1,1) lds=163840
.amdgcn_target "amdgcn-amd-amdhsa--gfx950"
.text
.globl sequential_preLN__grouped_kv_mqa__moe_arch_mod__prompt_kernel
.p2align 8
.type sequential_preLN__grouped_kv_mqa__moe_arch_mod__prompt_kernel,@function
sequential_preLN__grouped_kv_mqa__moe_arch_mod__prompt_kernel:
    s_cmp_ge_u32 s2, 256
    s_cbranch_scc1 L_END
    s_load_dwordx16 s[4:19], s[0:1], 0
    s_load_dwordx8 s[20:27], s[0:1], 64
    s_load_dwordx2 s[28:29], s[0:1], 96
    s_memrealtime s[94:95]
    v_lshrrev_b32 v1, 6, v0
    v_and_b32 v0, 63, v0
    v_readfirstlane_b32 s76, v1
    s_and_b32 s84, s2, 7
    s_lshl_b32 s84, s84, 5
    s_lshr_b32 s81, s2, 3
    s_add_u32 s81, s81, s84
    s_lshr_b32 s79, s81, 3
    s_and_b32 s80, s81, 7
    s_lshr_b32 s77, s76, 1
    s_lshr_b32 s78, s76, 2
    s_xor_b32 s78, s78, s76
    s_and_b32 s78, s78, 1
    s_lshl_b32 s30, s80, 1
    s_sub_u32 s98, s76, s30
    s_and_b32 s98, s98, 7
    s_cmp_lt_u32 s98, 2
    s_cselect_b32 s88, 1, 0
    s_cmp_lg_u32 s98, 7
    s_cbranch_scc1 L_NOPF
    s_getpc_b64 s[84:85]
L_PC:
    s_and_b32 s30, s81, 31
    s_mul_i32 s30, s30, 1152
    v_lshl_add_u32 v6, v0, 7, s30
    v_lshlrev_b32 v7, 4, v0
    v_mov_b32 v8, 0
    v_mov_b32 v9, 0
    v_add_u32 v7, 159744, v7
    ds_write_b64 v7, v[8:9]
    ds_write_b64 v7, v[8:9] offset:8
    v_min_u32 v6, L_CODE_END-L_PC-4, v6
    s_mov_b64 exec, 0x1ff
    global_load_dword v19, v6, s[84:85]
    s_mov_b64 exec, -1
L_NOPF:
    v_lshrrev_b32 v5, 3, v0
    v_and_b32 v6, 7, v0
    v_xor_b32 v6, v6, v5
    v_mul_u32_u24 v5, 1152, v5
    v_lshl_add_u32 v5, v6, 4, v5
    v_lshrrev_b32 v4, 2, v0
    v_mul_u32_u24 v4, 1152, v4
    v_and_b32 v6, 3, v0
    v_lshl_add_u32 v4, v6, 4, v4
    s_lshl_b32 s84, s79, 2
    s_add_u32 s84, s84, s77
    s_mul_i32 s84, s84, 18432
    s_mul_i32 s85, s78, 640
    s_add_u32 s99, s84, s85
    s_add_u32 s97, s99, 9216
    s_lshl_b32 s85, s78, 6
    s_add_u32 s96, s84, s85
    s_add_u32 s96, s96, 512
    s_mul_i32 s100, s98, 9216
    s_add_u32 s100, s100, 55296
    s_mov_b32 m0, s100
    v_lshlrev_b32 v12, 7, v0
    s_sub_u32 s84, s98, 2
    s_mul_i32 s92, s81, 9216
    s_mul_i32 s85, s84, 1536
    s_add_u32 s92, s92, s85
    s_and_b32 s93, s81, 31
    s_mul_i32 s93, s93, 20736
    s_mul_i32 s85, s84, 3456
    s_add_u32 s93, s93, s85
    s_and_b32 s101, s79, 3
    s_lshl_b32 s101, s101, 2
    s_and_b32 s85, s80, 3
    s_add_u32 s101, s101, s85
    s_mul_i32 s101, s101, 6
    s_add_u32 s101, s101, s84
    s_lshl_b32 s101, s101, 8
    s_setprio 2
    s_cmp_eq_u32 s88, 0
    s_cbranch_scc1 L_PRI
    s_setprio 3
L_PRI:
    s_waitcnt lgkmcnt(0)
    s_barrier
    s_mov_b32 s32, s4
    s_and_b32 s33, s5, 0xffff
    s_mov_b32 s34, 2359296
    s_mov_b32 s35, 0x20000
    buffer_load_dwordx4 v5, s[32:35], s99 offen offset:0 lds
    s_add_u32 m0, m0, 1024
    s_nop 0
    buffer_load_dwordx4 v5, s[32:35], s97 offen offset:0 lds
    s_add_u32 m0, m0, 896
    s_nop 0
    buffer_load_dwordx4 v5, s[32:35], s99 offen offset:128 lds
    s_add_u32 m0, m0, 1024
    s_nop 0
    buffer_load_dwordx4 v5, s[32:35], s97 offen offset:128 lds
    s_add_u32 m0, m0, 896
    s_nop 0
    buffer_load_dwordx4 v5, s[32:35], s99 offen offset:256 lds
    s_add_u32 m0, m0, 1024
    s_nop 0
    buffer_load_dwordx4 v5, s[32:35], s97 offen offset:256 lds
    s_add_u32 m0, m0, 896
    s_nop 0
    buffer_load_dwordx4 v5, s[32:35], s99 offen offset:384 lds
    s_add_u32 m0, m0, 1024
    s_nop 0
    buffer_load_dwordx4 v5, s[32:35], s97 offen offset:384 lds
    s_add_u32 m0, m0, 1408
    s_nop 0
    buffer_load_dwordx4 v4, s[32:35], s96 offen lds
    s_mov_b32 s72, s26
    s_and_b32 s73, s27, 0xffff
    s_mov_b32 s74, 256
    s_mov_b32 s75, 0x20000
    s_mov_b32 s68, s28
    s_and_b32 s69, s29, 0xffff
    s_mov_b32 s70, 4194304
    s_mov_b32 s71, 0x20000
    s_cmp_lg_u32 s2, 0
    s_cbranch_scc1 L_NONONCE
    s_cmp_lg_u32 s76, 7
    s_cbranch_scc1 L_NONONCE
    s_lshl_b32 s30, s94, 5
    s_or_b32 s30, s30, 1
    v_mov_b32 v8, s30
    v_mov_b32 v7, 0
    buffer_store_dword v8, v7, s[72:75], 0 offen sc1
L_NONONCE:
    s_cmp_lt_u32 s80, 4
    s_cselect_b32 s40, s8, s10
    s_cselect_b32 s41, s9, s11
    s_and_b32 s41, s41, 0xffff
    s_mov_b32 s42, 20736
    s_mov_b32 s43, 0x20000
    s_mov_b32 s36, s6
    s_and_b32 s37, s7, 0xffff
    s_mov_b32 s38, 663552
    s_mov_b32 s39, 0x20000
    s_mov_b32 s44, s12
    s_and_b32 s45, s13, 0xffff
    s_mov_b32 s46, 663552
    s_mov_b32 s47, 0x20000
    s_mov_b32 s48, s16
    s_and_b32 s49, s17, 0xffff
    s_mov_b32 s50, 1152
    s_mov_b32 s51, 0x20000
    s_mov_b32 s52, s18
    s_and_b32 s53, s19, 0xffff
    s_mov_b32 s54, 5308416
    s_mov_b32 s55, 0x20000
    s_mov_b32 s56, s20
    s_and_b32 s57, s21, 0xffff
    s_mov_b32 s58, 5308416
    s_mov_b32 s59, 0x20000
    s_mov_b32 s60, s22
    s_and_b32 s61, s23, 0xffff
    s_mov_b32 s62, 5308416
    s_mov_b32 s63, 0x20000
    s_mov_b32 s64, s24
    s_and_b32 s65, s25, 0xffff
    s_mov_b32 s66, 2359296
    s_mov_b32 s67, 0x20000
    v_and_b32 v2, 15, v0
    v_lshrrev_b32 v3, 4, v0
    s_mov_b32 s83, 0x3f803f80
    v_and_b32 v6, 7, v0
    v_xor_b32 v13, v6, v3
    v_lshlrev_b32 v13, 4, v13
    v_lshl_add_u32 v13, v6, 7, v13
    v_bfe_u32 v6, v0, 3, 1
    v_lshl_add_u32 v13, v6, 10, v13
    v_add_u32 v13, s100, v13
    v_xor_b32 v44, 64, v13
    v_lshlrev_b32 v45, 6, v2
    v_lshl_add_u32 v45, v3, 4, v45
    v_add_u32 v45, s100, v45
    s_sub_u32 s96, s98, 2
    s_mul_i32 s97, s80, 144
    s_cmp_lg_u32 s88, 0
    s_cbranch_scc1 L_KVPATH
    s_setprio 0
    s_cmp_lg_u32 s98, 99
    s_cbranch_scc1 L_NOWT
    s_and_b32 s84, s81, 31
    s_mul_i32 s84, s84, 20736
    v_lshlrev_b32 v6, 7, v0
    buffer_load_dword v19, v6, s[36:39], s84 offen
    v_add_u32 v6, 8192, v6
    buffer_load_dword v19, v6, s[36:39], s84 offen
    v_add_u32 v6, 8192, v6
    v_min_u32 v6, 20608, v6
    buffer_load_dword v19, v6, s[36:39], s84 offen
    s_lshr_b32 s84, s81, 3
    s_and_b32 s84, s84, 3
    s_and_b32 s85, s80, 3
    s_lshl_b32 s84, s84, 2
    s_add_u32 s84, s84, s85
    s_mul_i32 s84, s84, 1408
    v_lshlrev_b32 v6, 7, v0
    s_mov_b64 exec, 0x7ff
    buffer_load_dword v19, v6, s[40:43], s84 offen
    s_mov_b64 exec, -1
L_NOWT:
    s_cmp_lg_u32 s88, 0
    s_cbranch_scc1 L_DT
    s_mov_b64 exec, 0x7ffffff
    buffer_load_dword v19, v12, s[36:39], s93 offen
    s_mov_b64 exec, 3
    buffer_load_dword v19, v12, s[40:43], s101 offen
    s_mov_b64 exec, -1
L_DT:
    s_add_u32 s84, s96, 0
    s_cmp_ge_u32 s84, 9
    s_cselect_b32 s85, 9, 0
    s_sub_u32 s84, s84, s85
    s_lshl_b32 s84, s84, 6
    v_add_u32 v6, s84, v0
    v_mul_u32_u24 v7, 7282, v6
    v_lshrrev_b32 v7, 16, v7
    v_mul_u32_u24 v8, 9, v7
    v_sub_u32 v8, v6, v8
    v_mul_u32_u24 v9, 1152, v7
    v_lshl_add_u32 v40, v8, 4, v9
    s_add_u32 s84, s96, 6
    s_cmp_ge_u32 s84, 9
    s_cselect_b32 s85, 9, 0
    s_sub_u32 s84, s84, s85
    s_lshl_b32 s84, s84, 6
    v_add_u32 v6, s84, v0
    v_mul_u32_u24 v7, 7282, v6
    v_lshrrev_b32 v7, 16, v7
    v_mul_u32_u24 v8, 9, v7
    v_sub_u32 v8, v6, v8
    v_mul_u32_u24 v9, 1152, v7
    v_lshl_add_u32 v41, v8, 4, v9
    s_add_u32 s84, s96, 12
    s_cmp_ge_u32 s84, 9
    s_cselect_b32 s85, 9, 0
    s_sub_u32 s84, s84, s85
    s_lshl_b32 s84, s84, 6
    v_add_u32 v6, s84, v0
    v_mul_u32_u24 v7, 7282, v6
    v_lshrrev_b32 v7, 16, v7
    v_mul_u32_u24 v8, 9, v7
    v_sub_u32 v8, v6, v8
    v_mul_u32_u24 v9, 1152, v7
    v_lshl_add_u32 v42, v8, 4, v9
    s_cmp_ge_u32 s76, 4
    s_cbranch_scc1 L_PRE_1
    s_and_b32 s85, s76, 3
    s_add_u32 s85, s85, 0
    s_lshl_b32 s85, s85, 6
    v_add_u32 v6, s85, v0
    v_mul_u32_u24 v7, 7282, v6
    v_lshrrev_b32 v7, 16, v7
    v_mul_u32_u24 v8, 9, v7
    v_sub_u32 v8, v6, v8
    v_lshrrev_b32 v20, 4, v7
    v_mul_u32_u24 v20, 18, v20
    v_and_b32 v21, 1, v7
    v_lshl_add_u32 v20, v21, 3, v20
    v_bfe_u32 v22, v7, 3, 1
    v_lshl_add_u32 v20, v22, 2, v20
    v_bfe_u32 v22, v7, 1, 2
    v_add_u32 v20, v20, v22
    v_mul_u32_u24 v20, 1152, v20
    v_lshl_add_u32 v23, v8, 4, v20
    v_accvgpr_write_b32 a104, v23
    v_lshl_add_u32 v21, v21, 2, v22
    v_lshrrev_b32 v20, 3, v7
    v_mul_u32_u24 v20, 72, v20
    v_lshrrev_b32 v22, 1, v21
    v_mul_u32_u24 v22, 18, v22
    v_and_b32 v21, 1, v21
    v_add3_u32 v20, v20, v21, v22
    v_add_u32 v20, 16, v20
    v_mul_u32_u24 v20, 1152, v20
    v_lshl_add_u32 v23, v8, 4, v20
    v_accvgpr_write_b32 a105, v23
    s_and_b32 s85, s76, 3
    s_add_u32 s85, s85, 4
    s_lshl_b32 s85, s85, 6
    v_add_u32 v6, s85, v0
    v_mul_u32_u24 v7, 7282, v6
    v_lshrrev_b32 v7, 16, v7
    v_mul_u32_u24 v8, 9, v7
    v_sub_u32 v8, v6, v8
    v_lshrrev_b32 v20, 4, v7
    v_mul_u32_u24 v20, 18, v20
    v_and_b32 v21, 1, v7
    v_lshl_add_u32 v20, v21, 3, v20
    v_bfe_u32 v22, v7, 3, 1
    v_lshl_add_u32 v20, v22, 2, v20
    v_bfe_u32 v22, v7, 1, 2
    v_add_u32 v20, v20, v22
    v_mul_u32_u24 v20, 1152, v20
    v_lshl_add_u32 v23, v8, 4, v20
    v_accvgpr_write_b32 a106, v23
    v_lshl_add_u32 v21, v21, 2, v22
    v_lshrrev_b32 v20, 3, v7
    v_mul_u32_u24 v20, 72, v20
    v_lshrrev_b32 v22, 1, v21
    v_mul_u32_u24 v22, 18, v22
    v_and_b32 v21, 1, v21
    v_add3_u32 v20, v20, v21, v22
    v_add_u32 v20, 16, v20
    v_mul_u32_u24 v20, 1152, v20
    v_lshl_add_u32 v23, v8, 4, v20
    v_accvgpr_write_b32 a107, v23
    v_add_u32 v6, 512, v0
    v_mul_u32_u24 v7, 7282, v6
    v_lshrrev_b32 v7, 16, v7
    v_mul_u32_u24 v8, 9, v7
    v_sub_u32 v8, v6, v8
    v_lshrrev_b32 v20, 4, v7
    v_mul_u32_u24 v20, 18, v20
    v_and_b32 v21, 1, v7
    v_lshl_add_u32 v20, v21, 3, v20
    v_bfe_u32 v22, v7, 3, 1
    v_lshl_add_u32 v20, v22, 2, v20
    v_bfe_u32 v22, v7, 1, 2
    v_add_u32 v20, v20, v22
    v_mul_u32_u24 v20, 1152, v20
    v_lshl_add_u32 v23, v8, 4, v20
    v_accvgpr_write_b32 a108, v23
    v_lshl_add_u32 v21, v21, 2, v22
    v_lshrrev_b32 v20, 3, v7
    v_mul_u32_u24 v20, 72, v20
    v_lshrrev_b32 v22, 1, v21
    v_mul_u32_u24 v22, 18, v22
    v_and_b32 v21, 1, v21
    v_add3_u32 v20, v20, v21, v22
    v_add_u32 v20, 16, v20
    v_mul_u32_u24 v20, 1152, v20
    v_lshl_add_u32 v23, v8, 4, v20
    v_accvgpr_write_b32 a109, v23
    v_add_u32 v6, 0, v0
    v_mul_u32_u24 v7, 21846, v6
    v_lshrrev_b32 v7, 16, v7
    v_mul_u32_u24 v8, 3, v7
    v_sub_u32 v8, v6, v8
    v_mul_u32_u24 v7, 9216, v7
    v_lshlrev_b32 v8, 4, v8
    v_min_u32 v8, 20, v8
    v_add_u32 v8, v8, v7
    v_accvgpr_write_b32 a110, v8
    v_add_u32 v6, 64, v0
    v_mul_u32_u24 v7, 21846, v6
    v_lshrrev_b32 v7, 16, v7
    v_mul_u32_u24 v8, 3, v7
    v_sub_u32 v8, v6, v8
    v_mul_u32_u24 v7, 9216, v7
    v_lshlrev_b32 v8, 4, v8
    v_min_u32 v8, 20, v8
    v_add_u32 v8, v8, v7
    v_accvgpr_write_b32 a111, v8
    v_add_u32 v6, 128, v0
    v_mul_u32_u24 v7, 21846, v6
    v_lshrrev_b32 v7, 16, v7
    v_mul_u32_u24 v8, 3, v7
    v_sub_u32 v8, v6, v8
    v_mul_u32_u24 v7, 9216, v7
    v_lshlrev_b32 v8, 4, v8
    v_min_u32 v8, 20, v8
    v_add_u32 v8, v8, v7
    v_accvgpr_write_b32 a112, v8
    v_mul_u32_u24 v20, 1152, v2
    v_lshlrev_b32 v21, 3, v3
    v_add_u32 v20, v20, v21
    v_accvgpr_write_b32 a114, v20
L_PRE_1:
    s_and_b32 s85, s76, 3
    s_mul_i32 s84, s85, 36
    v_add_u32 v11, s84, v0
    v_lshrrev_b32 v15, 2, v11
    v_and_b32 v11, 3, v11
    v_lshlrev_b32 v15, 14, v15
    v_lshl_add_u32 v15, v11, 4, v15
    s_lshl_b32 s84, s81, 6
    s_add_u32 s84, s84, 3145728
    v_add_u32 v15, s84, v15
    v_cmp_gt_u32 vcc, 36, v0
    v_mov_b32 v11, 2146435072
    s_nop 0
    v_cndmask_b32 v15, v11, v15, vcc
    v_lshrrev_b32 v6, 2, v2
    v_lshlrev_b32 v6, 1, v6
    v_lshl_add_u32 v6, v3, 3, v6
    s_mul_i32 s84, 0, 288
    v_add_u32 v6, s84, v6
    v_and_b32 v7, 3, v0
    v_lshlrev_b32 v7, 3, v7
    v_mul_u32_u24 v6, 144, v6
    v_add_u32 v16, v6, v7
    s_lshr_b32 s85, s76, 2
    s_mul_i32 s85, s85, 41472
    v_add_u32 v20, s85, v16
    v_accvgpr_write_b32 a113, v20
    s_mul_i32 s85, s78, 4608
    v_add_u32 v61, s85, v16
    s_mul_i32 s85, s78, 46080
    v_add_u32 v16, s85, v16
    s_waitcnt vmcnt(9)
    ds_read_b128 v[64:67], v13 offset:0
    ds_read_b128 v[68:71], v44 offset:0
    s_waitcnt vmcnt(7)
    ds_read_b128 v[72:75], v13 offset:2048
    s_waitcnt lgkmcnt(2)
    v_dot2_f32_bf16 v48, v64, s83, 0
    v_dot2_f32_bf16 v49, v64, v64, 0
    v_dot2_f32_bf16 v48, v65, s83, v48
    v_dot2_f32_bf16 v49, v65, v65, v49
    v_dot2_f32_bf16 v48, v66, s83, v48
    v_dot2_f32_bf16 v49, v66, v66, v49
    v_dot2_f32_bf16 v48, v67, s83, v48
    v_dot2_f32_bf16 v49, v67, v67, v49
    ds_read_b128 v[76:79], v44 offset:2048
    s_waitcnt lgkmcnt(2)
    v_dot2_f32_bf16 v48, v68, s83, v48
    v_dot2_f32_bf16 v49, v68, v68, v49
    v_dot2_f32_bf16 v48, v69, s83, v48
    v_dot2_f32_bf16 v49, v69, v69, v49
    v_dot2_f32_bf16 v48, v70, s83, v48
    v_dot2_f32_bf16 v49, v70, v70, v49
    v_dot2_f32_bf16 v48, v71, s83, v48
    v_dot2_f32_bf16 v49, v71, v71, v49
    s_waitcnt vmcnt(5)
    ds_read_b128 v[80:83], v13 offset:4096
    s_waitcnt lgkmcnt(2)
    v_dot2_f32_bf16 v48, v72, s83, v48
    v_dot2_f32_bf16 v49, v72, v72, v49
    v_dot2_f32_bf16 v48, v73, s83, v48
    v_dot2_f32_bf16 v49, v73, v73, v49
    v_dot2_f32_bf16 v48, v74, s83, v48
    v_dot2_f32_bf16 v49, v74, v74, v49
    v_dot2_f32_bf16 v48, v75, s83, v48
    v_dot2_f32_bf16 v49, v75, v75, v49
    ds_read_b128 v[84:87], v44 offset:4096
    s_waitcnt lgkmcnt(2)
    v_dot2_f32_bf16 v48, v76, s83, v48
    v_dot2_f32_bf16 v49, v76, v76, v49
    v_dot2_f32_bf16 v48, v77, s83, v48
    v_dot2_f32_bf16 v49, v77, v77, v49
    v_dot2_f32_bf16 v48, v78, s83, v48
    v_dot2_f32_bf16 v49, v78, v78, v49
    v_dot2_f32_bf16 v48, v79, s83, v48
    v_dot2_f32_bf16 v49, v79, v79, v49
    s_waitcnt vmcnt(3)
    ds_read_b128 v[88:91], v13 offset:6144
    s_waitcnt lgkmcnt(2)
    v_dot2_f32_bf16 v48, v80, s83, v48
    v_dot2_f32_bf16 v49, v80, v80, v49
    v_dot2_f32_bf16 v48, v81, s83, v48
    v_dot2_f32_bf16 v49, v81, v81, v49
    v_dot2_f32_bf16 v48, v82, s83, v48
    v_dot2_f32_bf16 v49, v82, v82, v49
    v_dot2_f32_bf16 v48, v83, s83, v48
    v_dot2_f32_bf16 v49, v83, v83, v49
    ds_read_b128 v[92:95], v44 offset:6144
    s_waitcnt lgkmcnt(2)
    v_dot2_f32_bf16 v48, v84, s83, v48
    v_dot2_f32_bf16 v49, v84, v84, v49
    v_dot2_f32_bf16 v48, v85, s83, v48
    v_dot2_f32_bf16 v49, v85, v85, v49
    v_dot2_f32_bf16 v48, v86, s83, v48
    v_dot2_f32_bf16 v49, v86, v86, v49
    v_dot2_f32_bf16 v48, v87, s83, v48
    v_dot2_f32_bf16 v49, v87, v87, v49
    s_waitcnt vmcnt(2)
    ds_read_b128 v[96:99], v45 offset:8192
    s_waitcnt lgkmcnt(2)
    v_dot2_f32_bf16 v48, v88, s83, v48
    v_dot2_f32_bf16 v49, v88, v88, v49
    v_dot2_f32_bf16 v48, v89, s83, v48
    v_dot2_f32_bf16 v49, v89, v89, v49
    v_dot2_f32_bf16 v48, v90, s83, v48
    v_dot2_f32_bf16 v49, v90, v90, v49
    v_dot2_f32_bf16 v48, v91, s83, v48
    v_dot2_f32_bf16 v49, v91, v91, v49
    s_waitcnt lgkmcnt(1)
    v_dot2_f32_bf16 v48, v92, s83, v48
    v_dot2_f32_bf16 v49, v92, v92, v49
    v_dot2_f32_bf16 v48, v93, s83, v48
    v_dot2_f32_bf16 v49, v93, v93, v49
    v_dot2_f32_bf16 v48, v94, s83, v48
    v_dot2_f32_bf16 v49, v94, v94, v49
    v_dot2_f32_bf16 v48, v95, s83, v48
    v_dot2_f32_bf16 v49, v95, v95, v49
    s_waitcnt lgkmcnt(0)
    v_mov_b32 v12, 1
    v_mov_b32 v14, 159844
    s_cmp_ge_u32 s98, 3
    s_cbranch_scc1 L_NOCXA
    s_mov_b64 exec, 1
    ds_add_u32 v14, v12
    s_mov_b64 exec, -1
L_NOCXA:
    v_dot2_f32_bf16 v48, v96, s83, v48
    v_dot2_f32_bf16 v49, v96, v96, v49
    v_dot2_f32_bf16 v48, v97, s83, v48
    v_dot2_f32_bf16 v49, v97, v97, v49
    v_dot2_f32_bf16 v48, v98, s83, v48
    v_dot2_f32_bf16 v49, v98, v98, v49
    v_dot2_f32_bf16 v48, v99, s83, v48
    v_dot2_f32_bf16 v49, v99, v99, v49
    s_nop 1
    v_mov_b32 v50, v48
    v_mov_b32 v51, v49
    s_nop 0
    v_permlane32_swap_b32 v48, v50
    v_permlane32_swap_b32 v49, v51
    v_add_f32 v48, v48, v50
    v_add_f32 v49, v49, v51
    v_mov_b32 v50, v48
    v_mov_b32 v51, v49
    s_nop 0
    v_permlane16_swap_b32 v48, v50
    v_permlane16_swap_b32 v49, v51
    v_add_f32 v48, v48, v50
    v_add_f32 v49, v49, v51
    s_lshl_b32 s84, s76, 7
    s_add_u32 s84, s84, 158720
    v_lshl_add_u32 v6, v2, 3, s84
    s_lshl_b32 s84, s76, 2
    s_add_u32 s84, s84, 159808
    v_mov_b32 v7, s84
    ds_write_b64 v6, v[48:49]
    ds_write_b32 v7, v12
    v_xor_b32 v6, 128, v6
    v_xor_b32 v7, 4, v7
    v_mov_b32 v8, 0
    buffer_load_dword v10, v8, s[72:75], 0 offen sc1
    s_mov_b32 s89, 0
L_SXA:
    ds_read_b32 v8, v7
    ds_read_b64 v[50:51], v6
    s_waitcnt lgkmcnt(0)
    v_cmp_eq_u32 vcc, 0, v8
    s_cbranch_vccz L_SXDA
    s_add_u32 s89, s89, 1
    s_cmp_lt_u32 s89, 20000
    s_cbranch_scc1 L_SXA
L_SXDA:
    s_mul_i32 s92, s96, 7282
    s_lshr_b32 s92, s92, 16
    s_mul_i32 s92, s92, 73728
    s_add_u32 s92, s92, s97
    s_lshl_b32 m0, s96, 10
    s_add_u32 s96, s96, 6
    buffer_load_dwordx4 v40, s[36:39], s92 offen lds
    s_mul_i32 s92, s96, 7282
    s_lshr_b32 s92, s92, 16
    s_mul_i32 s92, s92, 73728
    s_add_u32 s92, s92, s97
    s_lshl_b32 m0, s96, 10
    s_add_u32 s96, s96, 6
    buffer_load_dwordx4 v41, s[36:39], s92 offen lds
    s_mul_i32 s92, s96, 7282
    s_lshr_b32 s92, s92, 16
    s_mul_i32 s92, s92, 73728
    s_add_u32 s92, s92, s97
    s_lshl_b32 m0, s96, 10
    s_add_u32 s96, s96, 6
    buffer_load_dwordx4 v42, s[36:39], s92 offen lds
    s_mul_i32 s92, s96, 7282
    s_lshr_b32 s92, s92, 16
    s_mul_i32 s92, s92, 73728
    s_add_u32 s92, s92, s97
    s_lshl_b32 m0, s96, 10
    s_add_u32 s96, s96, 6
    buffer_load_dwordx4 v40, s[36:39], s92 offen lds
    s_mul_i32 s92, s96, 7282
    s_lshr_b32 s92, s92, 16
    s_mul_i32 s92, s92, 73728
    s_add_u32 s92, s92, s97
    s_lshl_b32 m0, s96, 10
    s_add_u32 s96, s96, 6
    buffer_load_dwordx4 v41, s[36:39], s92 offen lds
    s_mul_i32 s92, s96, 7282
    s_lshr_b32 s92, s92, 16
    s_mul_i32 s92, s92, 73728
    s_add_u32 s92, s92, s97
    s_lshl_b32 m0, s96, 10
    s_add_u32 s96, s96, 6
    buffer_load_dwordx4 v42, s[36:39], s92 offen lds
    s_mul_i32 s92, s96, 7282
    s_lshr_b32 s92, s92, 16
    s_mul_i32 s92, s92, 73728
    s_add_u32 s92, s92, s97
    s_lshl_b32 m0, s96, 10
    s_add_u32 s96, s96, 6
    buffer_load_dwordx4 v40, s[36:39], s92 offen lds
    v_add_f32 v48, v48, v50
    v_add_f32 v49, v49, v51
    v_mul_f32 v50, 0x3ae38e39, v48
    v_mul_f32 v51, 0x3ae38e39, v49
    v_fma_f32 v52, -v50, v50, v51
    v_max_f32 v52, 0, v52
    v_cvt_pk_bf16_f32 v52, v52, v50
    v_and_b32 v50, 0xffff0000, v52
    v_lshlrev_b32 v52, 16, v52
    v_add_f32 v52, 0x3727c5ac, v52
    v_cvt_pk_bf16_f32 v52, v52, v52
    v_lshlrev_b32 v52, 16, v52
    v_sqrt_f32 v52, v52
    s_nop 0
    v_cvt_pk_bf16_f32 v52, v52, v52
    v_lshlrev_b32 v52, 16, v52
    v_rcp_f32 v51, v52
    s_nop 0
    v_mul_f32 v48, v50, v51
    v_mov_b32 v50, v51
    v_sub_f32 v48, 0, v48
    v_mov_b32 v49, v48
    v_lshlrev_b32 v52, 16, v64
    v_and_b32 v56, 0xffff0000, v64
    v_lshlrev_b32 v53, 16, v65
    v_and_b32 v57, 0xffff0000, v65
    v_lshlrev_b32 v54, 16, v66
    v_and_b32 v58, 0xffff0000, v66
    v_lshlrev_b32 v55, 16, v67
    v_and_b32 v59, 0xffff0000, v67
    s_mul_i32 s92, s96, 7282
    s_lshr_b32 s92, s92, 16
    s_mul_i32 s92, s92, 73728
    s_add_u32 s92, s92, s97
    s_lshl_b32 m0, s96, 10
    s_add_u32 s96, s96, 6
    buffer_load_dwordx4 v41, s[36:39], s92 offen lds
    v_pk_fma_f32 v[52:53], v[52:53], v[50:51], v[48:49]
    v_pk_fma_f32 v[54:55], v[54:55], v[50:51], v[48:49]
    v_pk_fma_f32 v[56:57], v[56:57], v[50:51], v[48:49]
    v_pk_fma_f32 v[58:59], v[58:59], v[50:51], v[48:49]
    v_cvt_pk_bf16_f32 v64, v52, v53
    v_cvt_pk_bf16_f32 v65, v54, v55
    v_cvt_pk_bf16_f32 v66, v56, v57
    v_cvt_pk_bf16_f32 v67, v58, v59
    s_mul_i32 s92, s96, 7282
    s_lshr_b32 s92, s92, 16
    s_mul_i32 s92, s92, 73728
    s_add_u32 s92, s92, s97
    s_lshl_b32 m0, s96, 10
    s_add_u32 s96, s96, 6
    buffer_load_dwordx4 v42, s[36:39], s92 offen lds
    v_lshlrev_b32 v52, 16, v68
    v_and_b32 v56, 0xffff0000, v68
    v_lshlrev_b32 v53, 16, v69
    v_and_b32 v57, 0xffff0000, v69
    v_lshlrev_b32 v54, 16, v70
    v_and_b32 v58, 0xffff0000, v70
    v_lshlrev_b32 v55, 16, v71
    v_and_b32 v59, 0xffff0000, v71
    s_mov_b32 s89, 0
L_CXW:
    ds_read_b32 v8, v14
    s_waitcnt lgkmcnt(0)
    v_cmp_gt_u32 vcc, 3, v8
    s_cbranch_vccz L_CXD
    s_add_u32 s89, s89, 1
    s_cmp_lt_u32 s89, 20000
    s_cbranch_scc1 L_CXW
L_CXD:
    s_mul_i32 s92, s96, 7282
    s_lshr_b32 s92, s92, 16
    s_mul_i32 s92, s92, 73728
    s_add_u32 s92, s92, s97
    s_lshl_b32 m0, s96, 10
    s_add_u32 s96, s96, 6
    buffer_load_dwordx4 v40, s[36:39], s92 offen lds
    v_pk_fma_f32 v[52:53], v[52:53], v[50:51], v[48:49]
    v_pk_fma_f32 v[54:55], v[54:55], v[50:51], v[48:49]
    v_pk_fma_f32 v[56:57], v[56:57], v[50:51], v[48:49]
    v_pk_fma_f32 v[58:59], v[58:59], v[50:51], v[48:49]
    v_cvt_pk_bf16_f32 v68, v52, v53
    v_cvt_pk_bf16_f32 v69, v54, v55
    v_cvt_pk_bf16_f32 v70, v56, v57
    v_cvt_pk_bf16_f32 v71, v58, v59
    s_mul_i32 s92, s96, 7282
    s_lshr_b32 s92, s92, 16
    s_mul_i32 s92, s92, 73728
    s_add_u32 s92, s92, s97
    s_lshl_b32 m0, s96, 10
    s_add_u32 s96, s96, 6
    buffer_load_dwordx4 v41, s[36:39], s92 offen lds
    v_lshlrev_b32 v52, 16, v72
    v_and_b32 v56, 0xffff0000, v72
    v_lshlrev_b32 v53, 16, v73
    v_and_b32 v57, 0xffff0000, v73
    v_lshlrev_b32 v54, 16, v74
    v_and_b32 v58, 0xffff0000, v74
    v_lshlrev_b32 v55, 16, v75
    v_and_b32 v59, 0xffff0000, v75
    s_mul_i32 s92, s96, 7282
    s_lshr_b32 s92, s92, 16
    s_mul_i32 s92, s92, 73728
    s_add_u32 s92, s92, s97
    s_lshl_b32 m0, s96, 10
    s_add_u32 s96, s96, 6
    buffer_load_dwordx4 v42, s[36:39], s92 offen lds
    v_pk_fma_f32 v[52:53], v[52:53], v[50:51], v[48:49]
    v_pk_fma_f32 v[54:55], v[54:55], v[50:51], v[48:49]
    v_pk_fma_f32 v[56:57], v[56:57], v[50:51], v[48:49]
    v_pk_fma_f32 v[58:59], v[58:59], v[50:51], v[48:49]
    v_cvt_pk_bf16_f32 v72, v52, v53
    v_cvt_pk_bf16_f32 v73, v54, v55
    v_cvt_pk_bf16_f32 v74, v56, v57
    v_cvt_pk_bf16_f32 v75, v58, v59
    s_mul_i32 s92, s96, 7282
    s_lshr_b32 s92, s92, 16
    s_mul_i32 s92, s92, 73728
    s_add_u32 s92, s92, s97
    s_lshl_b32 m0, s96, 10
    s_add_u32 s96, s96, 6
    buffer_load_dwordx4 v40, s[36:39], s92 offen lds
    v_lshlrev_b32 v52, 16, v76
    v_and_b32 v56, 0xffff0000, v76
    v_lshlrev_b32 v53, 16, v77
    v_and_b32 v57, 0xffff0000, v77
    v_lshlrev_b32 v54, 16, v78
    v_and_b32 v58, 0xffff0000, v78
    v_lshlrev_b32 v55, 16, v79
    v_and_b32 v59, 0xffff0000, v79
    s_cmp_ge_u32 s96, 81
    s_cbranch_scc1 L_WQD
    s_mul_i32 s92, s96, 7282
    s_lshr_b32 s92, s92, 16
    s_mul_i32 s92, s92, 73728
    s_add_u32 s92, s92, s97
    s_lshl_b32 m0, s96, 10
    s_add_u32 s96, s96, 6
    buffer_load_dwordx4 v41, s[36:39], s92 offen lds
L_WQD:
    v_pk_fma_f32 v[52:53], v[52:53], v[50:51], v[48:49]
    v_pk_fma_f32 v[54:55], v[54:55], v[50:51], v[48:49]
    v_pk_fma_f32 v[56:57], v[56:57], v[50:51], v[48:49]
    v_pk_fma_f32 v[58:59], v[58:59], v[50:51], v[48:49]
    v_cvt_pk_bf16_f32 v76, v52, v53
    v_cvt_pk_bf16_f32 v77, v54, v55
    v_cvt_pk_bf16_f32 v78, v56, v57
    v_cvt_pk_bf16_f32 v79, v58, v59
    v_lshlrev_b32 v52, 16, v80
    v_and_b32 v56, 0xffff0000, v80
    v_lshlrev_b32 v53, 16, v81
    v_and_b32 v57, 0xffff0000, v81
    v_lshlrev_b32 v54, 16, v82
    v_and_b32 v58, 0xffff0000, v82
    v_lshlrev_b32 v55, 16, v83
    v_and_b32 v59, 0xffff0000, v83
    v_pk_fma_f32 v[52:53], v[52:53], v[50:51], v[48:49]
    v_pk_fma_f32 v[54:55], v[54:55], v[50:51], v[48:49]
    v_pk_fma_f32 v[56:57], v[56:57], v[50:51], v[48:49]
    v_pk_fma_f32 v[58:59], v[58:59], v[50:51], v[48:49]
    v_cvt_pk_bf16_f32 v80, v52, v53
    v_cvt_pk_bf16_f32 v81, v54, v55
    v_cvt_pk_bf16_f32 v82, v56, v57
    v_cvt_pk_bf16_f32 v83, v58, v59
    v_lshlrev_b32 v52, 16, v84
    v_and_b32 v56, 0xffff0000, v84
    v_lshlrev_b32 v53, 16, v85
    v_and_b32 v57, 0xffff0000, v85
    v_lshlrev_b32 v54, 16, v86
    v_and_b32 v58, 0xffff0000, v86
    v_lshlrev_b32 v55, 16, v87
    v_and_b32 v59, 0xffff0000, v87
    v_pk_fma_f32 v[52:53], v[52:53], v[50:51], v[48:49]
    v_pk_fma_f32 v[54:55], v[54:55], v[50:51], v[48:49]
    v_pk_fma_f32 v[56:57], v[56:57], v[50:51], v[48:49]
    v_pk_fma_f32 v[58:59], v[58:59], v[50:51], v[48:49]
    v_cvt_pk_bf16_f32 v84, v52, v53
    v_cvt_pk_bf16_f32 v85, v54, v55
    v_cvt_pk_bf16_f32 v86, v56, v57
    v_cvt_pk_bf16_f32 v87, v58, v59
    v_lshlrev_b32 v52, 16, v88
    v_and_b32 v56, 0xffff0000, v88
    v_lshlrev_b32 v53, 16, v89
    v_and_b32 v57, 0xffff0000, v89
    v_lshlrev_b32 v54, 16, v90
    v_and_b32 v58, 0xffff0000, v90
    v_lshlrev_b32 v55, 16, v91
    v_and_b32 v59, 0xffff0000, v91
    v_pk_fma_f32 v[52:53], v[52:53], v[50:51], v[48:49]
    v_pk_fma_f32 v[54:55], v[54:55], v[50:51], v[48:49]
    v_pk_fma_f32 v[56:57], v[56:57], v[50:51], v[48:49]
    v_pk_fma_f32 v[58:59], v[58:59], v[50:51], v[48:49]
    v_cvt_pk_bf16_f32 v88, v52, v53
    v_cvt_pk_bf16_f32 v89, v54, v55
    v_cvt_pk_bf16_f32 v90, v56, v57
    v_cvt_pk_bf16_f32 v91, v58, v59
    v_lshlrev_b32 v52, 16, v92
    v_and_b32 v56, 0xffff0000, v92
    v_lshlrev_b32 v53, 16, v93
    v_and_b32 v57, 0xffff0000, v93
    v_lshlrev_b32 v54, 16, v94
    v_and_b32 v58, 0xffff0000, v94
    v_lshlrev_b32 v55, 16, v95
    v_and_b32 v59, 0xffff0000, v95
    v_pk_fma_f32 v[52:53], v[52:53], v[50:51], v[48:49]
    v_pk_fma_f32 v[54:55], v[54:55], v[50:51], v[48:49]
    v_pk_fma_f32 v[56:57], v[56:57], v[50:51], v[48:49]
    v_pk_fma_f32 v[58:59], v[58:59], v[50:51], v[48:49]
    v_cvt_pk_bf16_f32 v92, v52, v53
    v_cvt_pk_bf16_f32 v93, v54, v55
    v_cvt_pk_bf16_f32 v94, v56, v57
    v_cvt_pk_bf16_f32 v95, v58, v59
    v_lshlrev_b32 v52, 16, v96
    v_and_b32 v56, 0xffff0000, v96
    v_lshlrev_b32 v53, 16, v97
    v_and_b32 v57, 0xffff0000, v97
    v_lshlrev_b32 v54, 16, v98
    v_and_b32 v58, 0xffff0000, v98
    v_lshlrev_b32 v55, 16, v99
    v_and_b32 v59, 0xffff0000, v99
    v_pk_fma_f32 v[52:53], v[52:53], v[50:51], v[48:49]
    v_pk_fma_f32 v[54:55], v[54:55], v[50:51], v[48:49]
    v_pk_fma_f32 v[56:57], v[56:57], v[50:51], v[48:49]
    v_pk_fma_f32 v[58:59], v[58:59], v[50:51], v[48:49]
    v_cvt_pk_bf16_f32 v96, v52, v53
    v_cvt_pk_bf16_f32 v97, v54, v55
    v_cvt_pk_bf16_f32 v98, v56, v57
    v_cvt_pk_bf16_f32 v99, v58, v59
    s_waitcnt vmcnt(4)
    v_mov_b32 v14, 159880
    s_mov_b64 exec, 1
    ds_add_u32 v14, v12
    s_mov_b64 exec, -1
    s_xor_b32 s88, s78, 1
    s_cmp_eq_u32 s78, 0
    s_cbranch_scc1 L_KVEND
    s_waitcnt vmcnt(0)
    v_mov_b32 v14, 159884
    s_mov_b64 exec, 1
    ds_add_u32 v14, v12
    s_mov_b64 exec, -1
    s_branch L_KVEND
L_KVPATH:
    v_add_u32 v6, 0, v0
    v_mul_u32_u24 v7, 21846, v6
    v_lshrrev_b32 v7, 16, v7
    v_mul_u32_u24 v8, 3, v7
    v_sub_u32 v8, v6, v8
    v_mul_u32_u24 v7, 36, v7
    v_lshl_add_u32 v40, v8, 4, v7
    v_add_u32 v6, 64, v0
    v_mul_u32_u24 v7, 21846, v6
    v_lshrrev_b32 v7, 16, v7
    v_mul_u32_u24 v8, 3, v7
    v_sub_u32 v8, v6, v8
    v_mul_u32_u24 v7, 36, v7
    v_lshl_add_u32 v41, v8, 4, v7
    v_add_u32 v6, 128, v0
    v_mul_u32_u24 v7, 21846, v6
    v_lshrrev_b32 v7, 16, v7
    v_mul_u32_u24 v8, 3, v7
    v_sub_u32 v8, v6, v8
    v_mul_u32_u24 v7, 36, v7
    v_lshl_add_u32 v42, v8, 4, v7
    s_mul_i32 s85, s78, 10368
    s_mul_i32 s30, s78, 13824
    s_add_u32 s30, s30, 129024
    s_mov_b32 s96, s85
    s_mov_b32 s97, s30
    s_cmp_ge_u32 s76, 4
    s_cbranch_scc1 L_PRE_2
    s_and_b32 s85, s76, 3
    s_add_u32 s85, s85, 0
    s_lshl_b32 s85, s85, 6
    v_add_u32 v6, s85, v0
    v_mul_u32_u24 v7, 7282, v6
    v_lshrrev_b32 v7, 16, v7
    v_mul_u32_u24 v8, 9, v7
    v_sub_u32 v8, v6, v8
    v_lshrrev_b32 v20, 4, v7
    v_mul_u32_u24 v20, 18, v20
    v_and_b32 v21, 1, v7
    v_lshl_add_u32 v20, v21, 3, v20
    v_bfe_u32 v22, v7, 3, 1
    v_lshl_add_u32 v20, v22, 2, v20
    v_bfe_u32 v22, v7, 1, 2
    v_add_u32 v20, v20, v22
    v_mul_u32_u24 v20, 1152, v20
    v_lshl_add_u32 v23, v8, 4, v20
    v_accvgpr_write_b32 a104, v23
    v_lshl_add_u32 v21, v21, 2, v22
    v_lshrrev_b32 v20, 3, v7
    v_mul_u32_u24 v20, 72, v20
    v_lshrrev_b32 v22, 1, v21
    v_mul_u32_u24 v22, 18, v22
    v_and_b32 v21, 1, v21
    v_add3_u32 v20, v20, v21, v22
    v_add_u32 v20, 16, v20
    v_mul_u32_u24 v20, 1152, v20
    v_lshl_add_u32 v23, v8, 4, v20
    v_accvgpr_write_b32 a105, v23
    s_and_b32 s85, s76, 3
    s_add_u32 s85, s85, 4
    s_lshl_b32 s85, s85, 6
    v_add_u32 v6, s85, v0
    v_mul_u32_u24 v7, 7282, v6
    v_lshrrev_b32 v7, 16, v7
    v_mul_u32_u24 v8, 9, v7
    v_sub_u32 v8, v6, v8
    v_lshrrev_b32 v20, 4, v7
    v_mul_u32_u24 v20, 18, v20
    v_and_b32 v21, 1, v7
    v_lshl_add_u32 v20, v21, 3, v20
    v_bfe_u32 v22, v7, 3, 1
    v_lshl_add_u32 v20, v22, 2, v20
    v_bfe_u32 v22, v7, 1, 2
    v_add_u32 v20, v20, v22
    v_mul_u32_u24 v20, 1152, v20
    v_lshl_add_u32 v23, v8, 4, v20
    v_accvgpr_write_b32 a106, v23
    v_lshl_add_u32 v21, v21, 2, v22
    v_lshrrev_b32 v20, 3, v7
    v_mul_u32_u24 v20, 72, v20
    v_lshrrev_b32 v22, 1, v21
    v_mul_u32_u24 v22, 18, v22
    v_and_b32 v21, 1, v21
    v_add3_u32 v20, v20, v21, v22
    v_add_u32 v20, 16, v20
    v_mul_u32_u24 v20, 1152, v20
    v_lshl_add_u32 v23, v8, 4, v20
    v_accvgpr_write_b32 a107, v23
    v_add_u32 v6, 512, v0
    v_mul_u32_u24 v7, 7282, v6
    v_lshrrev_b32 v7, 16, v7
    v_mul_u32_u24 v8, 9, v7
    v_sub_u32 v8, v6, v8
    v_lshrrev_b32 v20, 4, v7
    v_mul_u32_u24 v20, 18, v20
    v_and_b32 v21, 1, v7
    v_lshl_add_u32 v20, v21, 3, v20
    v_bfe_u32 v22, v7, 3, 1
    v_lshl_add_u32 v20, v22, 2, v20
    v_bfe_u32 v22, v7, 1, 2
    v_add_u32 v20, v20, v22
    v_mul_u32_u24 v20, 1152, v20
    v_lshl_add_u32 v23, v8, 4, v20
    v_accvgpr_write_b32 a108, v23
    v_lshl_add_u32 v21, v21, 2, v22
    v_lshrrev_b32 v20, 3, v7
    v_mul_u32_u24 v20, 72, v20
    v_lshrrev_b32 v22, 1, v21
    v_mul_u32_u24 v22, 18, v22
    v_and_b32 v21, 1, v21
    v_add3_u32 v20, v20, v21, v22
    v_add_u32 v20, 16, v20
    v_mul_u32_u24 v20, 1152, v20
    v_lshl_add_u32 v23, v8, 4, v20
    v_accvgpr_write_b32 a109, v23
    v_add_u32 v6, 0, v0
    v_mul_u32_u24 v7, 21846, v6
    v_lshrrev_b32 v7, 16, v7
    v_mul_u32_u24 v8, 3, v7
    v_sub_u32 v8, v6, v8
    v_mul_u32_u24 v7, 9216, v7
    v_lshlrev_b32 v8, 4, v8
    v_min_u32 v8, 20, v8
    v_add_u32 v8, v8, v7
    v_accvgpr_write_b32 a110, v8
    v_add_u32 v6, 64, v0
    v_mul_u32_u24 v7, 21846, v6
    v_lshrrev_b32 v7, 16, v7
    v_mul_u32_u24 v8, 3, v7
    v_sub_u32 v8, v6, v8
    v_mul_u32_u24 v7, 9216, v7
    v_lshlrev_b32 v8, 4, v8
    v_min_u32 v8, 20, v8
    v_add_u32 v8, v8, v7
    v_accvgpr_write_b32 a111, v8
    v_add_u32 v6, 128, v0
    v_mul_u32_u24 v7, 21846, v6
    v_lshrrev_b32 v7, 16, v7
    v_mul_u32_u24 v8, 3, v7
    v_sub_u32 v8, v6, v8
    v_mul_u32_u24 v7, 9216, v7
    v_lshlrev_b32 v8, 4, v8
    v_min_u32 v8, 20, v8
    v_add_u32 v8, v8, v7
    v_accvgpr_write_b32 a112, v8
    v_mul_u32_u24 v20, 1152, v2
    v_lshlrev_b32 v21, 3, v3
    v_add_u32 v20, v20, v21
    v_accvgpr_write_b32 a114, v20
L_PRE_2:
    s_and_b32 s85, s76, 3
    s_mul_i32 s84, s85, 36
    v_add_u32 v11, s84, v0
    v_lshrrev_b32 v15, 2, v11
    v_and_b32 v11, 3, v11
    v_lshlrev_b32 v15, 14, v15
    v_lshl_add_u32 v15, v11, 4, v15
    s_lshl_b32 s84, s81, 6
    s_add_u32 s84, s84, 3145728
    v_add_u32 v15, s84, v15
    v_cmp_gt_u32 vcc, 36, v0
    v_mov_b32 v11, 2146435072
    s_nop 0
    v_cndmask_b32 v15, v11, v15, vcc
    v_lshrrev_b32 v6, 2, v2
    v_lshlrev_b32 v6, 1, v6
    v_lshl_add_u32 v6, v3, 3, v6
    s_mul_i32 s84, 0, 288
    v_add_u32 v6, s84, v6
    v_and_b32 v7, 3, v0
    v_lshlrev_b32 v7, 3, v7
    v_mul_u32_u24 v6, 144, v6
    v_add_u32 v16, v6, v7
    s_lshr_b32 s85, s76, 2
    s_mul_i32 s85, s85, 41472
    v_add_u32 v20, s85, v16
    v_accvgpr_write_b32 a113, v20
    s_mul_i32 s85, s78, 4608
    v_add_u32 v61, s85, v16
    s_mul_i32 s85, s78, 46080
    v_add_u32 v16, s85, v16
    s_waitcnt vmcnt(7)
    ds_read_b128 v[64:67], v13 offset:0
    s_mov_b32 m0, s97
    s_add_u32 s97, s97, 1024
    buffer_load_dwordx4 v40, s[40:43], s96 offen lds
    ds_read_b128 v[68:71], v44 offset:0
    s_mov_b32 m0, s97
    s_add_u32 s97, s97, 1024
    buffer_load_dwordx4 v41, s[40:43], s96 offen lds
    s_waitcnt vmcnt(7)
    ds_read_b128 v[72:75], v13 offset:2048
    s_mov_b32 m0, s97
    s_add_u32 s97, s97, 1024
    buffer_load_dwordx4 v42, s[40:43], s96 offen lds
    s_add_u32 s96, s96, 2304
    s_waitcnt lgkmcnt(2)
    v_dot2_f32_bf16 v48, v64, s83, 0
    v_dot2_f32_bf16 v49, v64, v64, 0
    v_dot2_f32_bf16 v48, v65, s83, v48
    v_dot2_f32_bf16 v49, v65, v65, v49
    v_dot2_f32_bf16 v48, v66, s83, v48
    v_dot2_f32_bf16 v49, v66, v66, v49
    v_dot2_f32_bf16 v48, v67, s83, v48
    v_dot2_f32_bf16 v49, v67, v67, v49
    ds_read_b128 v[76:79], v44 offset:2048
    s_mov_b32 m0, s97
    s_add_u32 s97, s97, 1024
    buffer_load_dwordx4 v40, s[40:43], s96 offen lds
    s_waitcnt lgkmcnt(2)
    v_dot2_f32_bf16 v48, v68, s83, v48
    v_dot2_f32_bf16 v49, v68, v68, v49
    v_dot2_f32_bf16 v48, v69, s83, v48
    v_dot2_f32_bf16 v49, v69, v69, v49
    v_dot2_f32_bf16 v48, v70, s83, v48
    v_dot2_f32_bf16 v49, v70, v70, v49
    v_dot2_f32_bf16 v48, v71, s83, v48
    v_dot2_f32_bf16 v49, v71, v71, v49
    s_waitcnt vmcnt(7)
    ds_read_b128 v[80:83], v13 offset:4096
    s_mov_b32 m0, s97
    s_add_u32 s97, s97, 1024
    buffer_load_dwordx4 v41, s[40:43], s96 offen lds
    s_waitcnt lgkmcnt(2)
    v_dot2_f32_bf16 v48, v72, s83, v48
    v_dot2_f32_bf16 v49, v72, v72, v49
    v_dot2_f32_bf16 v48, v73, s83, v48
    v_dot2_f32_bf16 v49, v73, v73, v49
    v_dot2_f32_bf16 v48, v74, s83, v48
    v_dot2_f32_bf16 v49, v74, v74, v49
    v_dot2_f32_bf16 v48, v75, s83, v48
    v_dot2_f32_bf16 v49, v75, v75, v49
    ds_read_b128 v[84:87], v44 offset:4096
    s_mov_b32 m0, s97
    s_add_u32 s97, s97, 1024
    buffer_load_dwordx4 v42, s[40:43], s96 offen lds
    s_add_u32 s96, s96, 2304
    s_waitcnt lgkmcnt(2)
    v_dot2_f32_bf16 v48, v76, s83, v48
    v_dot2_f32_bf16 v49, v76, v76, v49
    v_dot2_f32_bf16 v48, v77, s83, v48
    v_dot2_f32_bf16 v49, v77, v77, v49
    v_dot2_f32_bf16 v48, v78, s83, v48
    v_dot2_f32_bf16 v49, v78, v78, v49
    v_dot2_f32_bf16 v48, v79, s83, v48
    v_dot2_f32_bf16 v49, v79, v79, v49
    s_waitcnt vmcnt(7)
    ds_read_b128 v[88:91], v13 offset:6144
    s_mov_b32 m0, s97
    s_add_u32 s97, s97, 1024
    buffer_load_dwordx4 v40, s[40:43], s96 offen lds
    s_waitcnt lgkmcnt(2)
    v_dot2_f32_bf16 v48, v80, s83, v48
    v_dot2_f32_bf16 v49, v80, v80, v49
    v_dot2_f32_bf16 v48, v81, s83, v48
    v_dot2_f32_bf16 v49, v81, v81, v49
    v_dot2_f32_bf16 v48, v82, s83, v48
    v_dot2_f32_bf16 v49, v82, v82, v49
    v_dot2_f32_bf16 v48, v83, s83, v48
    v_dot2_f32_bf16 v49, v83, v83, v49
    ds_read_b128 v[92:95], v44 offset:6144
    s_mov_b32 m0, s97
    s_add_u32 s97, s97, 1024
    buffer_load_dwordx4 v41, s[40:43], s96 offen lds
    s_waitcnt lgkmcnt(2)
    v_dot2_f32_bf16 v48, v84, s83, v48
    v_dot2_f32_bf16 v49, v84, v84, v49
    v_dot2_f32_bf16 v48, v85, s83, v48
    v_dot2_f32_bf16 v49, v85, v85, v49
    v_dot2_f32_bf16 v48, v86, s83, v48
    v_dot2_f32_bf16 v49, v86, v86, v49
    v_dot2_f32_bf16 v48, v87, s83, v48
    v_dot2_f32_bf16 v49, v87, v87, v49
    s_waitcnt vmcnt(8)
    ds_read_b128 v[96:99], v45 offset:8192
    s_mov_b32 m0, s97
    s_add_u32 s97, s97, 1024
    buffer_load_dwordx4 v42, s[40:43], s96 offen lds
    s_add_u32 s96, s96, 2304
    s_waitcnt lgkmcnt(2)
    v_dot2_f32_bf16 v48, v88, s83, v48
    v_dot2_f32_bf16 v49, v88, v88, v49
    v_dot2_f32_bf16 v48, v89, s83, v48
    v_dot2_f32_bf16 v49, v89, v89, v49
    v_dot2_f32_bf16 v48, v90, s83, v48
    v_dot2_f32_bf16 v49, v90, v90, v49
    v_dot2_f32_bf16 v48, v91, s83, v48
    v_dot2_f32_bf16 v49, v91, v91, v49
    s_waitcnt lgkmcnt(1)
    v_dot2_f32_bf16 v48, v92, s83, v48
    v_dot2_f32_bf16 v49, v92, v92, v49
    v_dot2_f32_bf16 v48, v93, s83, v48
    v_dot2_f32_bf16 v49, v93, v93, v49
    v_dot2_f32_bf16 v48, v94, s83, v48
    v_dot2_f32_bf16 v49, v94, v94, v49
    v_dot2_f32_bf16 v48, v95, s83, v48
    v_dot2_f32_bf16 v49, v95, v95, v49
    s_waitcnt lgkmcnt(0)
    v_mov_b32 v12, 1
    v_mov_b32 v14, 159844
    s_cmp_ge_u32 s98, 3
    s_cbranch_scc1 L_NOCXB
    s_mov_b64 exec, 1
    ds_add_u32 v14, v12
    s_mov_b64 exec, -1
L_NOCXB:
    v_dot2_f32_bf16 v48, v96, s83, v48
    v_dot2_f32_bf16 v49, v96, v96, v49
    v_dot2_f32_bf16 v48, v97, s83, v48
    v_dot2_f32_bf16 v49, v97, v97, v49
    v_dot2_f32_bf16 v48, v98, s83, v48
    v_dot2_f32_bf16 v49, v98, v98, v49
    v_dot2_f32_bf16 v48, v99, s83, v48
    v_dot2_f32_bf16 v49, v99, v99, v49
    s_nop 1
    v_mov_b32 v50, v48
    v_mov_b32 v51, v49
    s_nop 0
    v_permlane32_swap_b32 v48, v50
    v_permlane32_swap_b32 v49, v51
    v_add_f32 v48, v48, v50
    v_add_f32 v49, v49, v51
    v_mov_b32 v50, v48
    v_mov_b32 v51, v49
    s_nop 0
    v_permlane16_swap_b32 v48, v50
    v_permlane16_swap_b32 v49, v51
    v_add_f32 v48, v48, v50
    v_add_f32 v49, v49, v51
    s_lshl_b32 s84, s76, 7
    s_add_u32 s84, s84, 158720
    v_lshl_add_u32 v6, v2, 3, s84
    s_lshl_b32 s84, s76, 2
    s_add_u32 s84, s84, 159808
    v_mov_b32 v7, s84
    ds_write_b64 v6, v[48:49]
    ds_write_b32 v7, v12
    v_xor_b32 v6, 128, v6
    v_xor_b32 v7, 4, v7
    v_mov_b32 v8, 0
    buffer_load_dword v10, v8, s[72:75], 0 offen sc1
    s_mov_b32 s89, 0
L_SXB:
    ds_read_b32 v8, v7
    ds_read_b64 v[50:51], v6
    s_waitcnt lgkmcnt(0)
    v_cmp_eq_u32 vcc, 0, v8
    s_cbranch_vccz L_SXDB
    s_add_u32 s89, s89, 1
    s_cmp_lt_u32 s89, 20000
    s_cbranch_scc1 L_SXB
L_SXDB:
    s_mov_b32 m0, s97
    s_add_u32 s97, s97, 1024
    buffer_load_dwordx4 v40, s[40:43], s96 offen lds
    s_mov_b32 m0, s97
    s_add_u32 s97, s97, 1024
    buffer_load_dwordx4 v41, s[40:43], s96 offen lds
    s_mov_b32 m0, s97
    s_add_u32 s97, s97, 1024
    buffer_load_dwordx4 v42, s[40:43], s96 offen lds
    s_add_u32 s96, s96, 2304
    s_mov_b32 m0, s97
    s_add_u32 s97, s97, 1024
    buffer_load_dwordx4 v40, s[40:43], s96 offen lds
    s_mov_b32 m0, s97
    s_add_u32 s97, s97, 1024
    buffer_load_dwordx4 v41, s[40:43], s96 offen lds
    v_add_f32 v48, v48, v50
    v_add_f32 v49, v49, v51
    v_mul_f32 v50, 0x3ae38e39, v48
    v_mul_f32 v51, 0x3ae38e39, v49
    v_fma_f32 v52, -v50, v50, v51
    v_max_f32 v52, 0, v52
    v_cvt_pk_bf16_f32 v52, v52, v50
    v_and_b32 v50, 0xffff0000, v52
    v_lshlrev_b32 v52, 16, v52
    v_add_f32 v52, 0x3727c5ac, v52
    v_cvt_pk_bf16_f32 v52, v52, v52
    v_lshlrev_b32 v52, 16, v52
    v_sqrt_f32 v52, v52
    s_nop 0
    v_cvt_pk_bf16_f32 v52, v52, v52
    v_lshlrev_b32 v52, 16, v52
    v_rcp_f32 v51, v52
    s_nop 0
    v_mul_f32 v48, v50, v51
    v_mov_b32 v50, v51
    v_sub_f32 v48, 0, v48
    v_mov_b32 v49, v48
    v_lshlrev_b32 v52, 16, v64
    v_and_b32 v56, 0xffff0000, v64
    v_lshlrev_b32 v53, 16, v65
    v_and_b32 v57, 0xffff0000, v65
    v_lshlrev_b32 v54, 16, v66
    v_and_b32 v58, 0xffff0000, v66
    v_lshlrev_b32 v55, 16, v67
    v_and_b32 v59, 0xffff0000, v67
    v_pk_fma_f32 v[52:53], v[52:53], v[50:51], v[48:49]
    v_pk_fma_f32 v[54:55], v[54:55], v[50:51], v[48:49]
    v_pk_fma_f32 v[56:57], v[56:57], v[50:51], v[48:49]
    v_pk_fma_f32 v[58:59], v[58:59], v[50:51], v[48:49]
    v_cvt_pk_bf16_f32 v64, v52, v53
    v_cvt_pk_bf16_f32 v65, v54, v55
    v_cvt_pk_bf16_f32 v66, v56, v57
    v_cvt_pk_bf16_f32 v67, v58, v59
    v_lshlrev_b32 v52, 16, v68
    v_and_b32 v56, 0xffff0000, v68
    v_lshlrev_b32 v53, 16, v69
    v_and_b32 v57, 0xffff0000, v69
    v_lshlrev_b32 v54, 16, v70
    v_and_b32 v58, 0xffff0000, v70
    v_lshlrev_b32 v55, 16, v71
    v_and_b32 v59, 0xffff0000, v71
    v_pk_fma_f32 v[52:53], v[52:53], v[50:51], v[48:49]
    v_pk_fma_f32 v[54:55], v[54:55], v[50:51], v[48:49]
    v_pk_fma_f32 v[56:57], v[56:57], v[50:51], v[48:49]
    v_pk_fma_f32 v[58:59], v[58:59], v[50:51], v[48:49]
    v_cvt_pk_bf16_f32 v68, v52, v53
    v_cvt_pk_bf16_f32 v69, v54, v55
    v_cvt_pk_bf16_f32 v70, v56, v57
    v_cvt_pk_bf16_f32 v71, v58, v59
    v_lshlrev_b32 v52, 16, v72
    v_and_b32 v56, 0xffff0000, v72
    v_lshlrev_b32 v53, 16, v73
    v_and_b32 v57, 0xffff0000, v73
    v_lshlrev_b32 v54, 16, v74
    v_and_b32 v58, 0xffff0000, v74
    v_lshlrev_b32 v55, 16, v75
    v_and_b32 v59, 0xffff0000, v75
    v_pk_fma_f32 v[52:53], v[52:53], v[50:51], v[48:49]
    v_pk_fma_f32 v[54:55], v[54:55], v[50:51], v[48:49]
    v_pk_fma_f32 v[56:57], v[56:57], v[50:51], v[48:49]
    v_pk_fma_f32 v[58:59], v[58:59], v[50:51], v[48:49]
    v_cvt_pk_bf16_f32 v72, v52, v53
    v_cvt_pk_bf16_f32 v73, v54, v55
    v_cvt_pk_bf16_f32 v74, v56, v57
    v_cvt_pk_bf16_f32 v75, v58, v59
    v_lshlrev_b32 v52, 16, v76
    v_and_b32 v56, 0xffff0000, v76
    v_lshlrev_b32 v53, 16, v77
    v_and_b32 v57, 0xffff0000, v77
    v_lshlrev_b32 v54, 16, v78
    v_and_b32 v58, 0xffff0000, v78
    v_lshlrev_b32 v55, 16, v79
    v_and_b32 v59, 0xffff0000, v79
    v_pk_fma_f32 v[52:53], v[52:53], v[50:51], v[48:49]
    v_pk_fma_f32 v[54:55], v[54:55], v[50:51], v[48:49]
    v_pk_fma_f32 v[56:57], v[56:57], v[50:51], v[48:49]
    v_pk_fma_f32 v[58:59], v[58:59], v[50:51], v[48:49]
    v_cvt_pk_bf16_f32 v76, v52, v53
    v_cvt_pk_bf16_f32 v77, v54, v55
    v_cvt_pk_bf16_f32 v78, v56, v57
    v_cvt_pk_bf16_f32 v79, v58, v59
    v_lshlrev_b32 v52, 16, v80
    v_and_b32 v56, 0xffff0000, v80
    v_lshlrev_b32 v53, 16, v81
    v_and_b32 v57, 0xffff0000, v81
    v_lshlrev_b32 v54, 16, v82
    v_and_b32 v58, 0xffff0000, v82
    v_lshlrev_b32 v55, 16, v83
    v_and_b32 v59, 0xffff0000, v83
    v_pk_fma_f32 v[52:53], v[52:53], v[50:51], v[48:49]
    v_pk_fma_f32 v[54:55], v[54:55], v[50:51], v[48:49]
    v_pk_fma_f32 v[56:57], v[56:57], v[50:51], v[48:49]
    v_pk_fma_f32 v[58:59], v[58:59], v[50:51], v[48:49]
    v_cvt_pk_bf16_f32 v80, v52, v53
    v_cvt_pk_bf16_f32 v81, v54, v55
    v_cvt_pk_bf16_f32 v82, v56, v57
    v_cvt_pk_bf16_f32 v83, v58, v59
    v_lshlrev_b32 v52, 16, v84
    v_and_b32 v56, 0xffff0000, v84
    v_lshlrev_b32 v53, 16, v85
    v_and_b32 v57, 0xffff0000, v85
    v_lshlrev_b32 v54, 16, v86
    v_and_b32 v58, 0xffff0000, v86
    v_lshlrev_b32 v55, 16, v87
    v_and_b32 v59, 0xffff0000, v87
    v_pk_fma_f32 v[52:53], v[52:53], v[50:51], v[48:49]
    v_pk_fma_f32 v[54:55], v[54:55], v[50:51], v[48:49]
    v_pk_fma_f32 v[56:57], v[56:57], v[50:51], v[48:49]
    v_pk_fma_f32 v[58:59], v[58:59], v[50:51], v[48:49]
    v_cvt_pk_bf16_f32 v84, v52, v53
    v_cvt_pk_bf16_f32 v85, v54, v55
    v_cvt_pk_bf16_f32 v86, v56, v57
    v_cvt_pk_bf16_f32 v87, v58, v59
    v_lshlrev_b32 v52, 16, v88
    v_and_b32 v56, 0xffff0000, v88
    v_lshlrev_b32 v53, 16, v89
    v_and_b32 v57, 0xffff0000, v89
    v_lshlrev_b32 v54, 16, v90
    v_and_b32 v58, 0xffff0000, v90
    v_lshlrev_b32 v55, 16, v91
    v_and_b32 v59, 0xffff0000, v91
    v_pk_fma_f32 v[52:53], v[52:53], v[50:51], v[48:49]
    v_pk_fma_f32 v[54:55], v[54:55], v[50:51], v[48:49]
    v_pk_fma_f32 v[56:57], v[56:57], v[50:51], v[48:49]
    v_pk_fma_f32 v[58:59], v[58:59], v[50:51], v[48:49]
    v_cvt_pk_bf16_f32 v88, v52, v53
    v_cvt_pk_bf16_f32 v89, v54, v55
    v_cvt_pk_bf16_f32 v90, v56, v57
    v_cvt_pk_bf16_f32 v91, v58, v59
    v_lshlrev_b32 v52, 16, v92
    v_and_b32 v56, 0xffff0000, v92
    v_lshlrev_b32 v53, 16, v93
    v_and_b32 v57, 0xffff0000, v93
    v_lshlrev_b32 v54, 16, v94
    v_and_b32 v58, 0xffff0000, v94
    v_lshlrev_b32 v55, 16, v95
    v_and_b32 v59, 0xffff0000, v95
    v_pk_fma_f32 v[52:53], v[52:53], v[50:51], v[48:49]
    v_pk_fma_f32 v[54:55], v[54:55], v[50:51], v[48:49]
    v_pk_fma_f32 v[56:57], v[56:57], v[50:51], v[48:49]
    v_pk_fma_f32 v[58:59], v[58:59], v[50:51], v[48:49]
    v_cvt_pk_bf16_f32 v92, v52, v53
    v_cvt_pk_bf16_f32 v93, v54, v55
    v_cvt_pk_bf16_f32 v94, v56, v57
    v_cvt_pk_bf16_f32 v95, v58, v59
    v_lshlrev_b32 v52, 16, v96
    v_and_b32 v56, 0xffff0000, v96
    v_lshlrev_b32 v53, 16, v97
    v_and_b32 v57, 0xffff0000, v97
    v_lshlrev_b32 v54, 16, v98
    v_and_b32 v58, 0xffff0000, v98
    v_lshlrev_b32 v55, 16, v99
    v_and_b32 v59, 0xffff0000, v99
    v_pk_fma_f32 v[52:53], v[52:53], v[50:51], v[48:49]
    v_pk_fma_f32 v[54:55], v[54:55], v[50:51], v[48:49]
    v_pk_fma_f32 v[56:57], v[56:57], v[50:51], v[48:49]
    v_pk_fma_f32 v[58:59], v[58:59], v[50:51], v[48:49]
    v_cvt_pk_bf16_f32 v96, v52, v53
    v_cvt_pk_bf16_f32 v97, v54, v55
    v_cvt_pk_bf16_f32 v98, v56, v57
    v_cvt_pk_bf16_f32 v99, v58, v59
    v_lshrrev_b32 v6, 2, v2
    v_lshlrev_b32 v6, 1, v6
    v_lshl_add_u32 v6, v3, 3, v6
    s_mul_i32 s84, 0, 288
    v_add_u32 v6, s84, v6
    v_and_b32 v7, 3, v0
    v_lshlrev_b32 v7, 3, v7
    v_mul_u32_u24 v6, 48, v6
    v_add_u32 v17, v6, v7
    v_add_u32 v17, 129024, v17
    s_mul_i32 s85, s78, 1536
    v_add_u32 v60, s85, v17
    s_mul_i32 s85, s78, 15360
    v_add_u32 v17, s85, v17
    s_waitcnt vmcnt(0)
    s_cmp_lt_u32 s80, 4
    s_cbranch_scc0 L_KVV
    ds_read_b64_tr_b16 v[100:101], v17 offset:0
    ds_read_b64_tr_b16 v[102:103], v17 offset:48
    ds_read_b64_tr_b16 v[104:105], v17 offset:32
    ds_read_b64_tr_b16 v[106:107], v17 offset:80
    ds_read_b64_tr_b16 v[108:109], v17 offset:1536
    ds_read_b64_tr_b16 v[110:111], v17 offset:1584
    ds_read_b64_tr_b16 v[112:113], v17 offset:1568
    ds_read_b64_tr_b16 v[114:115], v17 offset:1616
    ds_read_b64_tr_b16 v[116:117], v17 offset:3072
    ds_read_b64_tr_b16 v[118:119], v17 offset:3120
    s_waitcnt lgkmcnt(8)
    v_mfma_f32_16x16x32_bf16 v[40:43], v[100:103], v[64:67], 0
    ds_read_b64_tr_b16 v[100:101], v17 offset:3104
    ds_read_b64_tr_b16 v[102:103], v17 offset:3152
    s_waitcnt lgkmcnt(8)
    v_mfma_f32_16x16x32_bf16 v[44:47], v[104:107], v[64:67], 0
    ds_read_b64_tr_b16 v[104:105], v17 offset:4608
    ds_read_b64_tr_b16 v[106:107], v17 offset:4656
    s_waitcnt lgkmcnt(8)
    v_mfma_f32_16x16x32_bf16 v[40:43], v[108:111], v[68:71], v[40:43]
    ds_read_b64_tr_b16 v[108:109], v17 offset:4640
    ds_read_b64_tr_b16 v[110:111], v17 offset:4688
    s_waitcnt lgkmcnt(8)
    v_mfma_f32_16x16x32_bf16 v[44:47], v[112:115], v[68:71], v[44:47]
    ds_read_b64_tr_b16 v[112:113], v17 offset:6144
    ds_read_b64_tr_b16 v[114:115], v17 offset:6192
    s_waitcnt lgkmcnt(8)
    v_mfma_f32_16x16x32_bf16 v[40:43], v[116:119], v[72:75], v[40:43]
    ds_read_b64_tr_b16 v[116:117], v17 offset:6176
    ds_read_b64_tr_b16 v[118:119], v17 offset:6224
    s_waitcnt lgkmcnt(8)
    v_mfma_f32_16x16x32_bf16 v[44:47], v[100:103], v[72:75], v[44:47]
    ds_read_b64_tr_b16 v[100:101], v17 offset:7680
    ds_read_b64_tr_b16 v[102:103], v17 offset:7728
    s_waitcnt lgkmcnt(8)
    v_mfma_f32_16x16x32_bf16 v[40:43], v[104:107], v[76:79], v[40:43]
    ds_read_b64_tr_b16 v[104:105], v17 offset:7712
    ds_read_b64_tr_b16 v[106:107], v17 offset:7760
    s_waitcnt lgkmcnt(8)
    v_mfma_f32_16x16x32_bf16 v[44:47], v[108:111], v[76:79], v[44:47]
    ds_read_b64_tr_b16 v[108:109], v17 offset:9216
    ds_read_b64_tr_b16 v[110:111], v17 offset:9264
    s_waitcnt lgkmcnt(8)
    v_mfma_f32_16x16x32_bf16 v[40:43], v[112:115], v[80:83], v[40:43]
    ds_read_b64_tr_b16 v[112:113], v17 offset:9248
    ds_read_b64_tr_b16 v[114:115], v17 offset:9296
    s_waitcnt lgkmcnt(8)
    v_mfma_f32_16x16x32_bf16 v[44:47], v[116:119], v[80:83], v[44:47]
    ds_read_b64_tr_b16 v[116:117], v17 offset:10752
    ds_read_b64_tr_b16 v[118:119], v17 offset:10800
    s_waitcnt lgkmcnt(8)
    v_mfma_f32_16x16x32_bf16 v[40:43], v[100:103], v[84:87], v[40:43]
    ds_read_b64_tr_b16 v[100:101], v17 offset:10784
    ds_read_b64_tr_b16 v[102:103], v17 offset:10832
    s_waitcnt lgkmcnt(8)
    v_mfma_f32_16x16x32_bf16 v[44:47], v[104:107], v[84:87], v[44:47]
    ds_read_b64_tr_b16 v[104:105], v60 offset:12288
    ds_read_b64_tr_b16 v[106:107], v60 offset:12336
    s_waitcnt lgkmcnt(8)
    v_mfma_f32_16x16x32_bf16 v[40:43], v[108:111], v[88:91], v[40:43]
    ds_read_b64_tr_b16 v[108:109], v60 offset:12320
    ds_read_b64_tr_b16 v[110:111], v60 offset:12368
    s_waitcnt lgkmcnt(8)
    v_mfma_f32_16x16x32_bf16 v[44:47], v[112:115], v[88:91], v[44:47]
    s_waitcnt lgkmcnt(6)
    v_mfma_f32_16x16x32_bf16 v[40:43], v[116:119], v[92:95], v[40:43]
    s_waitcnt lgkmcnt(4)
    v_mfma_f32_16x16x32_bf16 v[44:47], v[100:103], v[92:95], v[44:47]
    s_waitcnt lgkmcnt(2)
    v_mfma_f32_16x16x32_bf16 v[40:43], v[104:107], v[96:99], v[40:43]
    s_waitcnt lgkmcnt(0)
    v_mfma_f32_16x16x32_bf16 v[44:47], v[108:111], v[96:99], v[44:47]
    s_branch L_KVX
L_KVV:
    ds_read_b64_tr_b16 v[100:101], v17 offset:0
    ds_read_b64_tr_b16 v[102:103], v17 offset:48
    ds_read_b64_tr_b16 v[104:105], v17 offset:32
    ds_read_b64_tr_b16 v[106:107], v17 offset:80
    ds_read_b64_tr_b16 v[108:109], v17 offset:1536
    ds_read_b64_tr_b16 v[110:111], v17 offset:1584
    ds_read_b64_tr_b16 v[112:113], v17 offset:1568
    ds_read_b64_tr_b16 v[114:115], v17 offset:1616
    ds_read_b64_tr_b16 v[116:117], v17 offset:3072
    ds_read_b64_tr_b16 v[118:119], v17 offset:3120
    s_waitcnt lgkmcnt(8)
    v_mfma_f32_16x16x32_bf16 v[40:43], v[64:67], v[100:103], 0
    ds_read_b64_tr_b16 v[100:101], v17 offset:3104
    ds_read_b64_tr_b16 v[102:103], v17 offset:3152
    s_waitcnt lgkmcnt(8)
    v_mfma_f32_16x16x32_bf16 v[44:47], v[64:67], v[104:107], 0
    ds_read_b64_tr_b16 v[104:105], v17 offset:4608
    ds_read_b64_tr_b16 v[106:107], v17 offset:4656
    s_waitcnt lgkmcnt(8)
    v_mfma_f32_16x16x32_bf16 v[40:43], v[68:71], v[108:111], v[40:43]
    ds_read_b64_tr_b16 v[108:109], v17 offset:4640
    ds_read_b64_tr_b16 v[110:111], v17 offset:4688
    s_waitcnt lgkmcnt(8)
    v_mfma_f32_16x16x32_bf16 v[44:47], v[68:71], v[112:115], v[44:47]
    ds_read_b64_tr_b16 v[112:113], v17 offset:6144
    ds_read_b64_tr_b16 v[114:115], v17 offset:6192
    s_waitcnt lgkmcnt(8)
    v_mfma_f32_16x16x32_bf16 v[40:43], v[72:75], v[116:119], v[40:43]
    ds_read_b64_tr_b16 v[116:117], v17 offset:6176
    ds_read_b64_tr_b16 v[118:119], v17 offset:6224
    s_waitcnt lgkmcnt(8)
    v_mfma_f32_16x16x32_bf16 v[44:47], v[72:75], v[100:103], v[44:47]
    ds_read_b64_tr_b16 v[100:101], v17 offset:7680
    ds_read_b64_tr_b16 v[102:103], v17 offset:7728
    s_waitcnt lgkmcnt(8)
    v_mfma_f32_16x16x32_bf16 v[40:43], v[76:79], v[104:107], v[40:43]
    ds_read_b64_tr_b16 v[104:105], v17 offset:7712
    ds_read_b64_tr_b16 v[106:107], v17 offset:7760
    s_waitcnt lgkmcnt(8)
    v_mfma_f32_16x16x32_bf16 v[44:47], v[76:79], v[108:111], v[44:47]
    ds_read_b64_tr_b16 v[108:109], v17 offset:9216
    ds_read_b64_tr_b16 v[110:111], v17 offset:9264
    s_waitcnt lgkmcnt(8)
    v_mfma_f32_16x16x32_bf16 v[40:43], v[80:83], v[112:115], v[40:43]
    ds_read_b64_tr_b16 v[112:113], v17 offset:9248
    ds_read_b64_tr_b16 v[114:115], v17 offset:9296
    s_waitcnt lgkmcnt(8)
    v_mfma_f32_16x16x32_bf16 v[44:47], v[80:83], v[116:119], v[44:47]
    ds_read_b64_tr_b16 v[116:117], v17 offset:10752
    ds_read_b64_tr_b16 v[118:119], v17 offset:10800
    s_waitcnt lgkmcnt(8)
    v_mfma_f32_16x16x32_bf16 v[40:43], v[84:87], v[100:103], v[40:43]
    ds_read_b64_tr_b16 v[100:101], v17 offset:10784
    ds_read_b64_tr_b16 v[102:103], v17 offset:10832
    s_waitcnt lgkmcnt(8)
    v_mfma_f32_16x16x32_bf16 v[44:47], v[84:87], v[104:107], v[44:47]
    ds_read_b64_tr_b16 v[104:105], v60 offset:12288
    ds_read_b64_tr_b16 v[106:107], v60 offset:12336
    s_waitcnt lgkmcnt(8)
    v_mfma_f32_16x16x32_bf16 v[40:43], v[88:91], v[108:111], v[40:43]
    ds_read_b64_tr_b16 v[108:109], v60 offset:12320
    ds_read_b64_tr_b16 v[110:111], v60 offset:12368
    s_waitcnt lgkmcnt(8)
    v_mfma_f32_16x16x32_bf16 v[44:47], v[88:91], v[112:115], v[44:47]
    s_waitcnt lgkmcnt(6)
    v_mfma_f32_16x16x32_bf16 v[40:43], v[92:95], v[116:119], v[40:43]
    s_waitcnt lgkmcnt(4)
    v_mfma_f32_16x16x32_bf16 v[44:47], v[92:95], v[100:103], v[44:47]
    s_waitcnt lgkmcnt(2)
    v_mfma_f32_16x16x32_bf16 v[40:43], v[96:99], v[104:107], v[40:43]
    s_waitcnt lgkmcnt(0)
    v_mfma_f32_16x16x32_bf16 v[44:47], v[96:99], v[108:111], v[44:47]
L_KVX:
    v_lshlrev_b32 v6, 2, v0
    v_add_u32 v6, 159888, v6
    v_mov_b32 v7, 16
    s_mov_b64 exec, 3
    ds_add_u32 v6, v7
    s_mov_b64 exec, -1
    v_lshlrev_b32 v6, 4, v0
    v_add_u32 v6, 161792, v6
    v_mov_b32 v14, 159840
    s_mov_b32 s88, 0
    s_cmp_eq_u32 s78, 1
    s_cbranch_scc1 L_KVEPI
    ds_write_b128 v6, v[40:43]
    ds_write_b128 v6, v[44:47] offset:1024
    ds_write_b32 v14, v12
    s_branch L_KVEND2
L_KVEPI:
    v_lshrrev_b32 v7, 1, v3
    v_and_b32 v8, 1, v3
    v_lshlrev_b32 v7, 9, v7
    v_lshl_add_u32 v7, v8, 3, v7
    v_lshl_add_u32 v7, v2, 4, v7
    s_lshl_b32 s84, s79, 2
    s_add_u32 s84, s84, s77
    s_mov_b32 s89, 0
L_KVW:
    ds_read_b32 v8, v14
    ds_read_b128 v[48:51], v6
    ds_read_b128 v[52:55], v6 offset:1024
    s_waitcnt lgkmcnt(0)
    v_cmp_eq_u32 vcc, 0, v8
    s_cbranch_vccz L_KVWD
    s_add_u32 s89, s89, 1
    s_cmp_lt_u32 s89, 20000
    s_cbranch_scc1 L_KVW
L_KVWD:
    v_add_f32 v40, v40, v48
    v_add_f32 v41, v41, v49
    v_add_f32 v42, v42, v50
    v_add_f32 v43, v43, v51
    v_add_f32 v44, v44, v52
    v_add_f32 v45, v45, v53
    v_add_f32 v46, v46, v54
    v_add_f32 v47, v47, v55
    v_cvt_pk_bf16_f32 v48, v40, v41
    v_cvt_pk_bf16_f32 v49, v42, v43
    v_cvt_pk_bf16_f32 v50, v44, v45
    v_cvt_pk_bf16_f32 v51, v46, v47
    s_cmp_lt_u32 s80, 4
    s_cbranch_scc0 L_VEPI
    s_lshr_b32 s85, s84, 1
    s_lshl_b32 s85, s85, 10
    s_and_b32 s30, s84, 1
    s_lshl_b32 s30, s30, 8
    s_add_u32 s85, s85, s30
    s_add_u32 s85, s85, 32768
    buffer_store_dwordx2 v[48:49], v7, s[68:71], s85 offen sc1
    v_lshlrev_b32 v8, 2, v0
    v_cmp_gt_u32 vcc, 16, v0
    v_mov_b32 v9, 2146435072
    s_nop 0
    v_cndmask_b32 v8, v9, v8, vcc
    s_lshl_b32 s85, s84, 6
    s_add_u32 s85, s85, 98304
    buffer_store_dword v50, v8, s[68:71], s85 offen sc1
    v_mul_f32 v52, v44, v44
    v_fmac_f32 v52, v45, v45
    v_cndmask_b32 v52, 0, v52, vcc
    v_fmac_f32 v52, v40, v40
    v_fmac_f32 v52, v41, v41
    v_fmac_f32 v52, v42, v42
    v_fmac_f32 v52, v43, v43
    v_mov_b32 v53, v52
    s_nop 1
    v_permlane32_swap_b32 v52, v53
    v_add_f32 v52, v52, v53
    v_mov_b32 v53, v52
    s_nop 1
    v_permlane16_swap_b32 v52, v53
    v_add_f32 v52, v52, v53
    s_nop 1
    v_mov_b32_dpp v53, v52 row_ror:8 row_mask:0xf bank_mask:0xf
    v_max_u32 v52, v52, v53
    s_nop 1
    v_mov_b32_dpp v53, v52 row_ror:4 row_mask:0xf bank_mask:0xf
    v_max_u32 v52, v52, v53
    s_nop 1
    v_mov_b32_dpp v53, v52 row_ror:2 row_mask:0xf bank_mask:0xf
    v_max_u32 v52, v52, v53
    s_nop 1
    v_mov_b32_dpp v53, v52 row_ror:1 row_mask:0xf bank_mask:0xf
    v_max_u32 v52, v52, v53
    v_mov_b32 v19, v52
    s_branch L_KVFLAG
L_VEPI:
    s_lshl_b32 s85, s84, 10
    s_add_u32 s85, s85, 131072
    buffer_store_dwordx2 v[48:49], v7, s[68:71], s85 offen sc1
    v_cmp_eq_u32 vcc, 2, v2
    v_mov_b32 v9, s83
    s_nop 0
    v_cndmask_b32 v50, v50, v9, vcc
    v_cndmask_b32 v51, v51, v9, vcc
    v_add_u32 v8, 256, v7
    v_add_u32 v9, 288, v7
    v_cndmask_b32 v8, v8, v9, vcc
    v_cmp_gt_u32 vcc, 3, v2
    v_mov_b32 v9, 2146435072
    s_nop 0
    v_cndmask_b32 v8, v9, v8, vcc
    buffer_store_dwordx2 v[50:51], v8, s[68:71], s85 offen sc1
    v_mov_b32 v19, 0
L_KVFLAG:
    s_waitcnt vmcnt(0)
    v_readfirstlane_b32 s82, v10
    s_nop 0
    s_cmp_lg_u32 s82, 0
    s_cbranch_scc1 L_GOTNA
    s_mov_b32 s89, 0
L_NSPINA:
    v_mov_b32 v7, 0
    buffer_load_dword v10, v7, s[72:75], 0 offen sc1
    s_waitcnt vmcnt(0)
    v_cmp_eq_u32 vcc, 0, v10
    s_cbranch_vccz L_NDONEA
    s_add_u32 s89, s89, 1
    s_cmp_lt_u32 s89, 20000
    s_cbranch_scc1 L_NSPINA
L_NDONEA:
    v_readfirstlane_b32 s82, v10
L_GOTNA:
    s_nop 1
    v_mov_b32 v18, s82
    v_lshlrev_b32 v7, 3, v0
    s_lshl_b32 s84, s81, 7
    s_mov_b64 exec, 1
    buffer_store_dwordx2 v[18:19], v7, s[68:71], s84 offen sc1
    s_mov_b64 exec, -1
L_KVEND2:
L_KVEND:
    s_setprio 0
    v_and_b32 v8, 31, v0
    v_lshlrev_b32 v5, 4, v0
    v_lshlrev_b32 v18, 2, v0
    v_cmp_gt_u32 vcc, 18, v8
    v_cmp_eq_u32 s[84:85], 20, v8
    s_nop 0
    s_or_b64 vcc, vcc, s[84:85]
    v_mov_b32 v19, 2146435072
    v_cndmask_b32 v19, v19, v5, vcc
    v_lshlrev_b32 v17, 7, v8
    s_lshl_b32 s96, s76, 13
    s_add_u32 s96, s96, 32768
    s_add_u32 s97, s96, 4096
    s_lshl_b32 s98, s76, 14
    s_add_u32 s98, s98, 131072
    s_add_u32 s99, s98, 4096
    s_add_u32 s100, s98, 8192
    s_add_u32 s101, s98, 12288
    s_lshl_b32 s95, s76, 10
    s_add_u32 s95, s95, 98304
    s_lshl_b32 s94, s76, 12
    s_and_b32 s84, s81, 31
    s_lshl_b32 s85, s84, 8
    s_add_u32 s85, s85, s96
    v_lshl_add_u32 v14, v0, 7, s85
    s_lshl_b32 s85, s84, 9
    s_add_u32 s85, s85, s98
    s_sub_u32 s85, s85, 256
    v_lshl_add_u32 v13, v0, 7, s85
    v_cmp_gt_u32 vcc, 2, v0
    s_nop 1
    v_cndmask_b32 v14, v13, v14, vcc
    s_and_b32 s85, s84, 7
    s_lshl_b32 s85, s85, 7
    s_add_u32 s85, s85, s95
    v_mov_b32 v13, s85
    v_cmp_gt_u32 vcc, 6, v0
    s_nop 1
    v_cndmask_b32 v14, v13, v14, vcc
    s_lshl_b32 s84, s78, 2
    s_add_u32 s84, s84, 159880
    v_mov_b32 v9, s84
    s_mov_b32 s89, 0
L_CEW:
    ds_read_b32 v11, v9
    s_waitcnt lgkmcnt(0)
    v_cmp_gt_u32 vcc, 6, v11
    s_cbranch_vccz L_CEWD
    s_add_u32 s89, s89, 1
    s_cmp_lt_u32 s89, 20000
    s_cbranch_scc1 L_CEW
L_CEWD:
    ds_read_b64_tr_b16 v[100:101], v16 offset:0
    ds_read_b64_tr_b16 v[102:103], v16 offset:144
    ds_read_b64_tr_b16 v[104:105], v16 offset:32
    ds_read_b64_tr_b16 v[106:107], v16 offset:176
    ds_read_b64_tr_b16 v[108:109], v16 offset:64
    ds_read_b64_tr_b16 v[110:111], v16 offset:208
    ds_read_b64_tr_b16 v[112:113], v16 offset:96
    ds_read_b64_tr_b16 v[114:115], v16 offset:240
    ds_read_b64_tr_b16 v[116:117], v16 offset:128
    ds_read_b64_tr_b16 v[118:119], v16 offset:272
    s_waitcnt lgkmcnt(8)
    v_mfma_f32_16x16x32_bf16 v[20:23], v[100:103], v[64:67], 0
    ds_read_b64_tr_b16 v[100:101], v16 offset:4608
    ds_read_b64_tr_b16 v[102:103], v16 offset:4752
    s_waitcnt lgkmcnt(8)
    v_mfma_f32_16x16x32_bf16 v[24:27], v[104:107], v[64:67], 0
    ds_read_b64_tr_b16 v[104:105], v16 offset:4640
    ds_read_b64_tr_b16 v[106:107], v16 offset:4784
    s_waitcnt lgkmcnt(8)
    v_mfma_f32_16x16x32_bf16 v[28:31], v[108:111], v[64:67], 0
    ds_read_b64_tr_b16 v[108:109], v16 offset:4672
    ds_read_b64_tr_b16 v[110:111], v16 offset:4816
    s_waitcnt lgkmcnt(8)
    v_mfma_f32_16x16x32_bf16 v[32:35], v[112:115], v[64:67], 0
    ds_read_b64_tr_b16 v[112:113], v16 offset:4704
    ds_read_b64_tr_b16 v[114:115], v16 offset:4848
    s_waitcnt lgkmcnt(8)
    v_mfma_f32_16x16x32_bf16 v[36:39], v[116:119], v[64:67], 0
    ds_read_b64_tr_b16 v[116:117], v16 offset:4736
    ds_read_b64_tr_b16 v[118:119], v16 offset:4880
    s_waitcnt lgkmcnt(8)
    v_mfma_f32_16x16x32_bf16 v[20:23], v[100:103], v[68:71], v[20:23]
    ds_read_b64_tr_b16 v[100:101], v16 offset:9216
    ds_read_b64_tr_b16 v[102:103], v16 offset:9360
    s_waitcnt lgkmcnt(8)
    v_mfma_f32_16x16x32_bf16 v[24:27], v[104:107], v[68:71], v[24:27]
    ds_read_b64_tr_b16 v[104:105], v16 offset:9248
    ds_read_b64_tr_b16 v[106:107], v16 offset:9392
    s_waitcnt lgkmcnt(8)
    v_mfma_f32_16x16x32_bf16 v[28:31], v[108:111], v[68:71], v[28:31]
    ds_read_b64_tr_b16 v[108:109], v16 offset:9280
    ds_read_b64_tr_b16 v[110:111], v16 offset:9424
    s_waitcnt lgkmcnt(8)
    v_mfma_f32_16x16x32_bf16 v[32:35], v[112:115], v[68:71], v[32:35]
    ds_read_b64_tr_b16 v[112:113], v16 offset:9312
    ds_read_b64_tr_b16 v[114:115], v16 offset:9456
    s_cmp_eq_u32 s88, 0
    s_cbranch_scc1 L_NOCL
    s_waitcnt vmcnt(0)
    v_mov_b32 v9, 159884
    s_mov_b64 exec, 1
    ds_add_u32 v9, v12
    s_mov_b64 exec, -1
L_NOCL:
    s_waitcnt lgkmcnt(8)
    v_mfma_f32_16x16x32_bf16 v[36:39], v[116:119], v[68:71], v[36:39]
    ds_read_b64_tr_b16 v[116:117], v16 offset:9344
    ds_read_b64_tr_b16 v[118:119], v16 offset:9488
    s_waitcnt lgkmcnt(8)
    v_mfma_f32_16x16x32_bf16 v[20:23], v[100:103], v[72:75], v[20:23]
    ds_read_b64_tr_b16 v[100:101], v16 offset:13824
    ds_read_b64_tr_b16 v[102:103], v16 offset:13968
    s_waitcnt lgkmcnt(8)
    v_mfma_f32_16x16x32_bf16 v[24:27], v[104:107], v[72:75], v[24:27]
    ds_read_b64_tr_b16 v[104:105], v16 offset:13856
    ds_read_b64_tr_b16 v[106:107], v16 offset:14000
    s_waitcnt lgkmcnt(8)
    v_mfma_f32_16x16x32_bf16 v[28:31], v[108:111], v[72:75], v[28:31]
    ds_read_b64_tr_b16 v[108:109], v16 offset:13888
    ds_read_b64_tr_b16 v[110:111], v16 offset:14032
    s_waitcnt lgkmcnt(8)
    v_mfma_f32_16x16x32_bf16 v[32:35], v[112:115], v[72:75], v[32:35]
    ds_read_b64_tr_b16 v[112:113], v16 offset:13920
    ds_read_b64_tr_b16 v[114:115], v16 offset:14064
    s_waitcnt lgkmcnt(8)
    v_mfma_f32_16x16x32_bf16 v[36:39], v[116:119], v[72:75], v[36:39]
    ds_read_b64_tr_b16 v[116:117], v16 offset:13952
    ds_read_b64_tr_b16 v[118:119], v16 offset:14096
    s_waitcnt lgkmcnt(8)
    v_mfma_f32_16x16x32_bf16 v[20:23], v[100:103], v[76:79], v[20:23]
    ds_read_b64_tr_b16 v[100:101], v16 offset:18432
    ds_read_b64_tr_b16 v[102:103], v16 offset:18576
    s_waitcnt lgkmcnt(8)
    v_mfma_f32_16x16x32_bf16 v[24:27], v[104:107], v[76:79], v[24:27]
    ds_read_b64_tr_b16 v[104:105], v16 offset:18464
    ds_read_b64_tr_b16 v[106:107], v16 offset:18608
    s_waitcnt lgkmcnt(8)
    v_mfma_f32_16x16x32_bf16 v[28:31], v[108:111], v[76:79], v[28:31]
    ds_read_b64_tr_b16 v[108:109], v16 offset:18496
    ds_read_b64_tr_b16 v[110:111], v16 offset:18640
    s_waitcnt lgkmcnt(8)
    v_mfma_f32_16x16x32_bf16 v[32:35], v[112:115], v[76:79], v[32:35]
    ds_read_b64_tr_b16 v[112:113], v16 offset:18528
    ds_read_b64_tr_b16 v[114:115], v16 offset:18672
    s_waitcnt lgkmcnt(8)
    v_mfma_f32_16x16x32_bf16 v[36:39], v[116:119], v[76:79], v[36:39]
    ds_read_b64_tr_b16 v[116:117], v16 offset:18560
    ds_read_b64_tr_b16 v[118:119], v16 offset:18704
    s_waitcnt lgkmcnt(8)
    v_mfma_f32_16x16x32_bf16 v[20:23], v[100:103], v[80:83], v[20:23]
    ds_read_b64_tr_b16 v[100:101], v16 offset:23040
    ds_read_b64_tr_b16 v[102:103], v16 offset:23184
    s_waitcnt lgkmcnt(8)
    v_mfma_f32_16x16x32_bf16 v[24:27], v[104:107], v[80:83], v[24:27]
    ds_read_b64_tr_b16 v[104:105], v16 offset:23072
    ds_read_b64_tr_b16 v[106:107], v16 offset:23216
    s_waitcnt lgkmcnt(8)
    v_mfma_f32_16x16x32_bf16 v[28:31], v[108:111], v[80:83], v[28:31]
    ds_read_b64_tr_b16 v[108:109], v16 offset:23104
    ds_read_b64_tr_b16 v[110:111], v16 offset:23248
    s_waitcnt lgkmcnt(8)
    v_mfma_f32_16x16x32_bf16 v[32:35], v[112:115], v[80:83], v[32:35]
    ds_read_b64_tr_b16 v[112:113], v16 offset:23136
    ds_read_b64_tr_b16 v[114:115], v16 offset:23280
    s_waitcnt lgkmcnt(8)
    v_mfma_f32_16x16x32_bf16 v[36:39], v[116:119], v[80:83], v[36:39]
    ds_read_b64_tr_b16 v[116:117], v16 offset:23168
    ds_read_b64_tr_b16 v[118:119], v16 offset:23312
    s_waitcnt lgkmcnt(8)
    v_mfma_f32_16x16x32_bf16 v[20:23], v[100:103], v[84:87], v[20:23]
    ds_read_b64_tr_b16 v[100:101], v16 offset:27648
    ds_read_b64_tr_b16 v[102:103], v16 offset:27792
    s_waitcnt lgkmcnt(8)
    v_mfma_f32_16x16x32_bf16 v[24:27], v[104:107], v[84:87], v[24:27]
    ds_read_b64_tr_b16 v[104:105], v16 offset:27680
    ds_read_b64_tr_b16 v[106:107], v16 offset:27824
    s_waitcnt lgkmcnt(8)
    v_mfma_f32_16x16x32_bf16 v[28:31], v[108:111], v[84:87], v[28:31]
    ds_read_b64_tr_b16 v[108:109], v16 offset:27712
    ds_read_b64_tr_b16 v[110:111], v16 offset:27856
    s_waitcnt lgkmcnt(8)
    v_mfma_f32_16x16x32_bf16 v[32:35], v[112:115], v[84:87], v[32:35]
    ds_read_b64_tr_b16 v[112:113], v16 offset:27744
    ds_read_b64_tr_b16 v[114:115], v16 offset:27888
    s_waitcnt lgkmcnt(8)
    v_mfma_f32_16x16x32_bf16 v[36:39], v[116:119], v[84:87], v[36:39]
    ds_read_b64_tr_b16 v[116:117], v16 offset:27776
    ds_read_b64_tr_b16 v[118:119], v16 offset:27920
    s_waitcnt lgkmcnt(8)
    v_mfma_f32_16x16x32_bf16 v[20:23], v[100:103], v[88:91], v[20:23]
    ds_read_b64_tr_b16 v[100:101], v16 offset:32256
    ds_read_b64_tr_b16 v[102:103], v16 offset:32400
    s_waitcnt lgkmcnt(8)
    v_mfma_f32_16x16x32_bf16 v[24:27], v[104:107], v[88:91], v[24:27]
    ds_read_b64_tr_b16 v[104:105], v16 offset:32288
    ds_read_b64_tr_b16 v[106:107], v16 offset:32432
    s_waitcnt lgkmcnt(8)
    v_mfma_f32_16x16x32_bf16 v[28:31], v[108:111], v[88:91], v[28:31]
    ds_read_b64_tr_b16 v[108:109], v16 offset:32320
    ds_read_b64_tr_b16 v[110:111], v16 offset:32464
    s_waitcnt lgkmcnt(8)
    v_mfma_f32_16x16x32_bf16 v[32:35], v[112:115], v[88:91], v[32:35]
    ds_read_b64_tr_b16 v[112:113], v16 offset:32352
    ds_read_b64_tr_b16 v[114:115], v16 offset:32496
    s_waitcnt lgkmcnt(8)
    v_mfma_f32_16x16x32_bf16 v[36:39], v[116:119], v[88:91], v[36:39]
    ds_read_b64_tr_b16 v[116:117], v16 offset:32384
    ds_read_b64_tr_b16 v[118:119], v16 offset:32528
    s_waitcnt lgkmcnt(8)
    v_mfma_f32_16x16x32_bf16 v[20:23], v[100:103], v[92:95], v[20:23]
    ds_read_b64_tr_b16 v[100:101], v61 offset:36864
    ds_read_b64_tr_b16 v[102:103], v61 offset:37008
    s_waitcnt lgkmcnt(8)
    v_mfma_f32_16x16x32_bf16 v[24:27], v[104:107], v[92:95], v[24:27]
    ds_read_b64_tr_b16 v[104:105], v61 offset:36896
    ds_read_b64_tr_b16 v[106:107], v61 offset:37040
    s_waitcnt lgkmcnt(8)
    v_mfma_f32_16x16x32_bf16 v[28:31], v[108:111], v[92:95], v[28:31]
    ds_read_b64_tr_b16 v[108:109], v61 offset:36928
    ds_read_b64_tr_b16 v[110:111], v61 offset:37072
    s_waitcnt lgkmcnt(8)
    v_mfma_f32_16x16x32_bf16 v[32:35], v[112:115], v[92:95], v[32:35]
    ds_read_b64_tr_b16 v[112:113], v61 offset:36960
    ds_read_b64_tr_b16 v[114:115], v61 offset:37104
    s_waitcnt lgkmcnt(8)
    v_mfma_f32_16x16x32_bf16 v[36:39], v[116:119], v[92:95], v[36:39]
    ds_read_b64_tr_b16 v[116:117], v61 offset:36992
    ds_read_b64_tr_b16 v[118:119], v61 offset:37136
    s_waitcnt lgkmcnt(8)
    v_mfma_f32_16x16x32_bf16 v[20:23], v[100:103], v[96:99], v[20:23]
    s_waitcnt vmcnt(0)
    v_readfirstlane_b32 s82, v10
    s_nop 0
    s_cmp_lg_u32 s82, 0
    s_cbranch_scc1 L_GOTNB
    s_mov_b32 s89, 0
L_NSPINB:
    v_mov_b32 v7, 0
    buffer_load_dword v10, v7, s[72:75], 0 offen sc1
    s_waitcnt vmcnt(0)
    v_cmp_eq_u32 vcc, 0, v10
    s_cbranch_vccz L_NDONEB
    s_add_u32 s89, s89, 1
    s_cmp_lt_u32 s89, 20000
    s_cbranch_scc1 L_NSPINB
L_NDONEB:
    v_readfirstlane_b32 s82, v10
L_GOTNB:
    buffer_load_dwordx2 v[124:125], v17, s[68:71], s94 offen sc1
    s_waitcnt lgkmcnt(6)
    v_mfma_f32_16x16x32_bf16 v[24:27], v[104:107], v[96:99], v[24:27]
    s_waitcnt lgkmcnt(4)
    v_mfma_f32_16x16x32_bf16 v[28:31], v[108:111], v[96:99], v[28:31]
    s_waitcnt lgkmcnt(2)
    v_mfma_f32_16x16x32_bf16 v[32:35], v[112:115], v[96:99], v[32:35]
    s_waitcnt lgkmcnt(0)
    v_mfma_f32_16x16x32_bf16 v[36:39], v[116:119], v[96:99], v[36:39]
    s_mul_i32 s84, s78, 19456
    s_add_u32 s84, s84, 82944
    s_mul_i32 s85, s77, 4864
    s_add_u32 s85, s85, s84
    v_mul_u32_u24 v6, 304, v2
    v_lshl_add_u32 v6, v3, 4, v6
    v_add_u32 v6, s85, v6
    ds_write_b128 v6, v[20:23] offset:0
    ds_write_b128 v6, v[24:27] offset:64
    ds_write_b128 v6, v[28:31] offset:128
    ds_write_b128 v6, v[32:35] offset:192
    s_mov_b32 exec_hi, 0
    ds_write_b128 v6, v[36:39] offset:256
    s_mov_b64 exec, -1
    s_lshr_b32 s84, s76, 2
    s_lshl_b32 s84, s84, 2
    s_add_u32 s84, s84, 159888
    v_mov_b32 v13, s84
    s_mov_b64 exec, 1
    ds_add_u32 v13, v12
    s_mov_b64 exec, -1
    s_and_b32 s3, s76, 3
    s_lshl_b32 s3, s3, 1
    s_lshr_b32 s84, s76, 2
    s_add_u32 s3, s3, s84
    s_lshl_b32 s85, s84, 8
    s_add_u32 s85, s85, 161024
    s_mul_i32 s84, s84, 9728
    s_lshr_b32 s30, s3, 1
    s_mul_i32 s30, s30, 72
    s_add_u32 s30, s30, 82944
    s_add_u32 s84, s84, s30
    s_add_u32 s30, s30, 19456
    v_lshrrev_b32 v9, 5, v0
    v_mul_u32_u24 v6, 304, v8
    v_add_u32 v6, s84, v6
    v_lshl_add_u32 v7, v9, 5, v6
    s_mul_i32 s84, s3, 1280
    v_add_u32 v9, 146432, v5
    v_lshlrev_b32 v10, 3, v8
    v_add_u32 v10, 147456, v10
    v_add_u32 v98, s84, v9
    v_add_u32 v99, s84, v10
    v_mov_b32 v100, 0x3eae1a93
    v_mov_b32 v101, v100
    v_mov_b32 v102, 159872
    v_mov_b32 v103, 0
    s_mov_b32 s86, 0
    s_mov_b32 s87, -1
    s_add_u32 s90, s3, 1
    s_add_u32 s91, s3, 2
    s_mov_b32 s88, 1
    s_cmp_ge_u32 s76, 4
    s_cbranch_scc1 L_NOEARLY
    v_mov_b32 v4, 0xdddddddd
    v_mov_b32 v40, 0
    v_mov_b32 v41, 0
    v_mov_b32 v42, 0
    v_mov_b32 v43, 0
    v_mov_b32 v44, 0
    v_mov_b32 v45, 0
    v_mov_b32 v46, 0
    v_mov_b32 v47, 0
    v_mov_b32 v48, 0
    v_mov_b32 v49, 0
    v_mov_b32 v50, 0
    v_mov_b32 v51, 0
    v_mov_b32 v52, 0
    v_mov_b32 v53, 0
    v_mov_b32 v54, 0
    v_mov_b32 v55, 0
    v_mov_b32 v56, 0
    v_mov_b32 v57, 0
    v_mov_b32 v58, 0
    v_mov_b32 v59, 0
    v_mov_b32 v60, 0
    v_mov_b32 v61, 0
    v_mov_b32 v62, 0
    v_mov_b32 v63, 0
    s_waitcnt vmcnt(0)
    v_cmp_ne_u32 vcc, s82, v124
    s_cbranch_vccz L_EARLYOK
    s_mov_b32 s89, 0
L_ES:
    buffer_load_dwordx2 v[124:125], v17, s[68:71], s94 offen sc1
    s_waitcnt vmcnt(0)
    v_cmp_ne_u32 vcc, s82, v124
    s_cbranch_vccz L_EARLYOK
    s_add_u32 s89, s89, 1
    s_cmp_lt_u32 s89, 1
    s_cbranch_scc1 L_ES
    s_branch L_NOEARLY
L_EARLYOK:
    s_mov_b32 s88, 0
    s_mov_b64 exec, 0x7f
    buffer_load_dword a124, v14, s[68:71], 0 offen sc1
    s_mov_b64 exec, -1
    buffer_load_dword a96, v18, s[68:71], s95 offen offset:0 sc1
    buffer_load_dwordx4 a[64:67], v5, s[68:71], s96 offen offset:0 sc1
    buffer_load_dwordx4 a[68:71], v5, s[68:71], s96 offen offset:1024 sc1
    buffer_load_dword a98, v18, s[68:71], s95 offen offset:256 sc1
    buffer_load_dwordx4 a[0:3], v19, s[68:71], s98 offen offset:0 sc1
    buffer_load_dwordx4 a[4:7], v19, s[68:71], s98 offen offset:1024 sc1
    buffer_load_dwordx4 a[72:75], v5, s[68:71], s96 offen offset:2048 sc1
    buffer_load_dwordx4 a[76:79], v5, s[68:71], s96 offen offset:3072 sc1
    buffer_load_dwordx4 a[8:11], v19, s[68:71], s98 offen offset:2048 sc1
    buffer_load_dwordx4 a[12:15], v19, s[68:71], s98 offen offset:3072 sc1
L_NOEARLY:
    s_mov_b32 s89, 0
L_QCW:
    ds_read_b32 v11, v13
    s_waitcnt lgkmcnt(0)
    v_cmp_gt_u32 vcc, 36, v11
    s_cbranch_vccz L_QCWD
    s_add_u32 s89, s89, 1
    s_cmp_lt_u32 s89, 20000
    s_cbranch_scc1 L_QCW
L_QCWD:
    ds_read_b64 v[104:105], v7 offset:0
    ds_read_b64 v[106:107], v7 offset:8
    ds_read_b64 v[108:109], v7 offset:16
    ds_read_b64 v[110:111], v7 offset:24
    ds_read_b64 v[112:113], v6 offset:64
    ds_read_b64 v[114:115], v7 offset:19456
    ds_read_b64 v[116:117], v7 offset:19464
    ds_read_b64 v[118:119], v7 offset:19472
    ds_read_b64 v[120:121], v7 offset:19480
    ds_read_b64 v[122:123], v6 offset:19520
    v_mov_b32 v32, 0
    v_mov_b32 v33, 0
    v_mov_b32 v34, 0
    v_mov_b32 v35, 0
    v_mov_b32 v36, 0
    v_mov_b32 v37, 0
    v_mov_b32 v38, 0
    v_mov_b32 v39, 0
    s_mul_i32 s84, s3, 3072
    s_add_u32 s84, s84, 121856
    v_add_u32 v7, s84, v5
    s_waitcnt lgkmcnt(0)
    v_pk_add_f32 v[104:105], v[104:105], v[114:115]
    v_pk_add_f32 v[106:107], v[106:107], v[116:117]
    v_pk_add_f32 v[108:109], v[108:109], v[118:119]
    v_pk_add_f32 v[110:111], v[110:111], v[120:121]
    v_pk_add_f32 v[112:113], v[112:113], v[122:123]
    v_pk_mul_f32 v[104:105], v[104:105], v[100:101]
    v_pk_mul_f32 v[106:107], v[106:107], v[100:101]
    v_pk_mul_f32 v[108:109], v[108:109], v[100:101]
    v_pk_mul_f32 v[110:111], v[110:111], v[100:101]
    v_pk_mul_f32 v[112:113], v[112:113], v[100:101]
    v_pk_mul_f32 v[114:115], v[104:105], v[104:105]
    v_pk_mul_f32 v[116:117], v[106:107], v[106:107]
    v_pk_fma_f32 v[114:115], v[108:109], v[108:109], v[114:115]
    v_pk_fma_f32 v[116:117], v[110:111], v[110:111], v[116:117]
    v_mul_f32 v118, v112, v112
    v_pk_add_f32 v[114:115], v[114:115], v[116:117]
    v_fmac_f32 v118, v113, v113
    v_add_f32 v114, v114, v115
    v_cvt_pk_bf16_f32 v20, v104, v105
    v_mov_b32 v115, v114
    v_cvt_pk_bf16_f32 v21, v106, v107
    v_cvt_pk_bf16_f32 v22, v108, v109
    v_permlane32_swap_b32 v114, v115
    v_cvt_pk_bf16_f32 v23, v110, v111
    v_add_f32 v118, v118, v114
    v_add_f32 v118, v118, v115
    v_sqrt_f32 v118, v118
    v_cvt_pk_bf16_f32 v24, v112, v113
    ds_write_b128 v98, v[20:23]
    v_mov_b32 v25, 0xc2400000
    ds_write_b32 v7, v103 offset:2052
    v_max_u32_dpp v118, v118, v118 row_ror:8 row_mask:0xf bank_mask:0xf
    s_mov_b32 exec_hi, 0
    ds_write_b64 v99, v[24:25]
    v_max_u32_dpp v118, v118, v118 row_ror:4 row_mask:0xf bank_mask:0xf
    s_mov_b32 exec_lo, 0x000f000f
    ds_max_u32 v102, v118 offset:4
    s_mov_b64 exec, -1
    s_cmp_eq_u32 s88, 0
    s_cbranch_scc1 L_S1OK
    s_waitcnt vmcnt(0)
    v_cmp_ne_u32 vcc, s82, v124
    s_cbranch_vccz L_S1OK
    s_mov_b32 s89, 0
L_S1:
    buffer_load_dwordx2 v[124:125], v17, s[68:71], s94 offen sc1
    s_waitcnt vmcnt(0)
    v_cmp_ne_u32 vcc, s82, v124
    s_cbranch_vccz L_S1OK
    s_add_u32 s89, s89, 1
    s_cmp_lt_u32 s89, 20000
    s_cbranch_scc1 L_S1
L_S1OK:
    s_mov_b64 exec, 0x0f0f0f0f
    ds_max_u32 v102, v125
    s_mov_b64 exec, -1
    v_add_u32 v17, 121856, v5
    s_cmp_eq_u32 s88, 0
    s_cbranch_scc1 L_KVIN
    s_mov_b64 exec, 0x7f
    buffer_load_dword a124, v14, s[68:71], 0 offen sc1
    s_mov_b64 exec, -1
    s_cmp_ge_u32 s76, 4
    s_cbranch_scc1 L_KVIN
    buffer_load_dword a96, v18, s[68:71], s95 offen offset:0 sc1
    buffer_load_dwordx4 a[64:67], v5, s[68:71], s96 offen offset:0 sc1
    buffer_load_dwordx4 a[68:71], v5, s[68:71], s96 offen offset:1024 sc1
    buffer_load_dword a98, v18, s[68:71], s95 offen offset:256 sc1
    buffer_load_dwordx4 a[0:3], v19, s[68:71], s98 offen offset:0 sc1
    buffer_load_dwordx4 a[4:7], v19, s[68:71], s98 offen offset:1024 sc1
    buffer_load_dwordx4 a[72:75], v5, s[68:71], s96 offen offset:2048 sc1
    buffer_load_dwordx4 a[76:79], v5, s[68:71], s96 offen offset:3072 sc1
    buffer_load_dwordx4 a[8:11], v19, s[68:71], s98 offen offset:2048 sc1
    buffer_load_dwordx4 a[12:15], v19, s[68:71], s98 offen offset:3072 sc1
L_KVIN:
    v_mov_b32 v103, 1.0
    v_mov_b32 v11, v102
    v_accvgpr_write_b32 a97, v103
    v_accvgpr_write_b32 a99, v103
    v_accvgpr_write_b32 a101, v103
    v_accvgpr_write_b32 a103, v103
    s_mov_b32 s93, 1
    s_cmp_lt_u32 s76, 4
    s_cbranch_scc1 L_MAIN
    s_mov_b32 s93, 0
    s_waitcnt lgkmcnt(0)
    s_barrier
    ds_read_b64 v[12:13], v11
    s_waitcnt lgkmcnt(0)
    v_sqrt_f32 v12, v12
    s_mov_b32 s84, 0x42400000
    v_mul_f32 v13, v13, v12
    v_cmp_nge_f32 vcc, s84, v13
    s_cbranch_vccnz L_SLOW
L_MAIN:
    s_mov_b64 vcc, 0
    s_cmp_lt_u32 s76, 4
    s_cbranch_scc1 L_OLD
    v_mov_b32 v4, 0xdddddddd
    v_mov_b32 v40, 0
    v_mov_b32 v41, 0
    v_mov_b32 v42, 0
    v_mov_b32 v43, 0
    v_mov_b32 v44, 0
    v_mov_b32 v45, 0
    v_mov_b32 v46, 0
    v_mov_b32 v47, 0
    v_mov_b32 v48, 0
    v_mov_b32 v49, 0
    v_mov_b32 v50, 0
    v_mov_b32 v51, 0
    v_mov_b32 v52, 0
    v_mov_b32 v53, 0
    v_mov_b32 v54, 0
    v_mov_b32 v55, 0
    v_mov_b32 v56, 0
    v_mov_b32 v57, 0
    v_mov_b32 v58, 0
    v_mov_b32 v59, 0
    v_mov_b32 v60, 0
    v_mov_b32 v61, 0
    v_mov_b32 v62, 0
    v_mov_b32 v63, 0
    v_subrev_u32 v31, 1020, v7
    s_mov_b32 s89, 0
L_YW:
    s_sleep 2
    ds_read_b32 v1, v31
    s_waitcnt lgkmcnt(0)
    v_cmp_eq_u32 vcc, 0, v1
    s_mov_b32 vcc_lo, 0
    s_cbranch_vccz L_YWOK
    s_add_u32 s89, s89, 1
    s_cmp_lt_u32 s89, 20000
    s_cbranch_scc1 L_YW
L_YWOK:
    buffer_load_dword a96, v18, s[68:71], s95 offen offset:0 sc1
    buffer_load_dwordx4 a[64:67], v5, s[68:71], s96 offen offset:0 sc1
    buffer_load_dwordx4 a[68:71], v5, s[68:71], s96 offen offset:1024 sc1
    buffer_load_dword a98, v18, s[68:71], s95 offen offset:256 sc1
    buffer_load_dwordx4 a[0:3], v19, s[68:71], s98 offen offset:0 sc1
    buffer_load_dwordx4 a[4:7], v19, s[68:71], s98 offen offset:1024 sc1
    buffer_load_dwordx4 a[72:75], v5, s[68:71], s96 offen offset:2048 sc1
    buffer_load_dwordx4 a[76:79], v5, s[68:71], s96 offen offset:3072 sc1
    buffer_load_dwordx4 a[8:11], v19, s[68:71], s98 offen offset:2048 sc1
    buffer_load_dwordx4 a[12:15], v19, s[68:71], s98 offen offset:3072 sc1
    buffer_load_dword a100, v18, s[68:71], s95 offen offset:512 sc1
    buffer_load_dwordx4 a[16:19], v19, s[68:71], s99 offen offset:0 sc1
    buffer_load_dwordx4 a[20:23], v19, s[68:71], s99 offen offset:1024 sc1
    buffer_load_dwordx4 a[80:83], v5, s[68:71], s97 offen offset:0 sc1
    buffer_load_dwordx4 a[84:87], v5, s[68:71], s97 offen offset:1024 sc1
    buffer_load_dwordx4 a[24:27], v19, s[68:71], s99 offen offset:2048 sc1
    buffer_load_dwordx4 a[28:31], v19, s[68:71], s99 offen offset:3072 sc1
    buffer_load_dword a102, v18, s[68:71], s95 offen offset:768 sc1
    buffer_load_dwordx4 a[32:35], v19, s[68:71], s100 offen offset:0 sc1
    buffer_load_dwordx4 a[36:39], v19, s[68:71], s100 offen offset:1024 sc1
    buffer_load_dwordx4 a[88:91], v5, s[68:71], s97 offen offset:2048 sc1
    buffer_load_dwordx4 a[92:95], v5, s[68:71], s97 offen offset:3072 sc1
    buffer_load_dwordx4 a[40:43], v19, s[68:71], s100 offen offset:2048 sc1
    buffer_load_dwordx4 a[44:47], v19, s[68:71], s100 offen offset:3072 sc1
    buffer_load_dwordx4 a[48:51], v19, s[68:71], s101 offen offset:0 sc1
    buffer_load_dwordx4 a[52:55], v19, s[68:71], s101 offen offset:1024 sc1
    buffer_load_dwordx4 a[56:59], v19, s[68:71], s101 offen offset:2048 sc1
    buffer_load_dwordx4 a[60:63], v19, s[68:71], s101 offen offset:3072 sc1
    s_sub_u32 s96, s76, 4
    s_mul_i32 s96, s96, 41
    v_add_u32 v11, s96, v0
    v_min_u32 v11, 161, v11
    v_lshlrev_b32 v12, 7, v11
    v_mul_u32_u24 v13, 7282, v11
    v_lshrrev_b32 v13, 16, v13
    v_mul_u32_u24 v14, 9, v13
    v_sub_u32 v14, v11, v14
    v_mul_u32_u24 v13, 9216, v13
    v_lshl_add_u32 v13, v14, 7, v13
    s_and_b32 s96, s81, 31
    s_mul_i32 s96, s96, 165888
    s_lshr_b32 s97, s81, 5
    s_mul_i32 s97, s97, 1152
    s_add_u32 s96, s96, s97
    s_mul_i32 s97, s81, 20736
    s_and_b32 s98, s81, 31
    s_mul_i32 s98, s98, 20736
    s_mov_b32 exec_hi, 0x1ff
    buffer_load_dword a124, v12, s[44:47], s98 offen
    buffer_load_dword a124, v13, s[52:55], s96 offen
    buffer_load_dword a124, v13, s[56:59], s96 offen
    buffer_load_dword a124, v12, s[60:63], s97 offen
    s_mov_b64 exec, -1
    s_mov_b64 vcc, -1
L_OLD:
    s_waitcnt lgkmcnt(0)
    s_waitcnt vmcnt(9)
    v_mfma_f32_32x32x4_2b_bf16 v[64:95], a[96:97], v[24:25], 0
    s_waitcnt vmcnt(8)
    s_nop 15
    s_nop 0
    v_mfma_f32_32x32x16_bf16 v[64:79], a[64:67], v[20:23], v[64:79]
    s_waitcnt vmcnt(7)
    v_mfma_f32_32x32x16_bf16 v[80:95], a[68:71], v[20:23], v[80:95]
    s_nop 9
    v_exp_f32 v64, v64
    v_exp_f32 v65, v65
    v_exp_f32 v66, v66
    v_exp_f32 v67, v67
    v_exp_f32 v68, v68
    s_cbranch_vccnz L_KV_3
    buffer_load_dword a100, v18, s[68:71], s95 offen offset:512 sc1
    buffer_load_dwordx4 a[16:19], v19, s[68:71], s99 offen offset:0 sc1
L_KV_3:
    s_waitcnt vmcnt(8)
    v_mfma_f32_32x32x4_2b_bf16 v[96:127], a[98:99], v[24:25], 0
    v_exp_f32 v69, v69
    v_exp_f32 v70, v70
    v_exp_f32 v71, v71
    v_exp_f32 v72, v72
    v_exp_f32 v73, v73
    s_cbranch_vccnz L_KV_4
    buffer_load_dwordx4 a[20:23], v19, s[68:71], s99 offen offset:1024 sc1
    buffer_load_dwordx4 a[80:83], v5, s[68:71], s97 offen offset:0 sc1
L_KV_4:
    v_exp_f32 v74, v74
    v_exp_f32 v75, v75
    v_exp_f32 v76, v76
    s_waitcnt vmcnt(9)
    v_smfmac_f32_32x32x32_bf16 v[32:47], a[0:3], v[64:71], v4
    v_exp_f32 v77, v77
    v_exp_f32 v78, v78
    s_cbranch_vccnz L_KV_5
    buffer_load_dwordx4 a[84:87], v5, s[68:71], s97 offen offset:1024 sc1
    buffer_load_dwordx4 a[24:27], v19, s[68:71], s99 offen offset:2048 sc1
L_KV_5:
    v_exp_f32 v79, v79
    v_exp_f32 v80, v80
    v_exp_f32 v81, v81
    s_waitcnt vmcnt(10)
    v_smfmac_f32_32x32x32_bf16 v[32:47], a[4:7], v[72:79], v4
    v_exp_f32 v82, v82
    v_exp_f32 v83, v83
    s_cbranch_vccnz L_KV_6
    buffer_load_dwordx4 a[28:31], v19, s[68:71], s99 offen offset:3072 sc1
    buffer_load_dword a102, v18, s[68:71], s95 offen offset:768 sc1
L_KV_6:
    v_exp_f32 v84, v84
    s_waitcnt vmcnt(11)
    v_mfma_f32_32x32x16_bf16 v[96:111], a[72:75], v[20:23], v[96:111]
    v_exp_f32 v85, v85
    v_exp_f32 v86, v86
    v_exp_f32 v87, v87
    v_exp_f32 v88, v88
    s_cbranch_vccnz L_KV_7
    buffer_load_dwordx4 a[32:35], v19, s[68:71], s100 offen offset:0 sc1
    buffer_load_dwordx4 a[36:39], v19, s[68:71], s100 offen offset:1024 sc1
L_KV_7:
    s_waitcnt vmcnt(12)
    v_mfma_f32_32x32x16_bf16 v[112:127], a[76:79], v[20:23], v[112:127]
    v_exp_f32 v89, v89
    v_exp_f32 v90, v90
    v_exp_f32 v91, v91
    s_waitcnt vmcnt(11)
    v_smfmac_f32_32x32x32_bf16 v[32:47], a[8:11], v[80:87], v4
    v_exp_f32 v92, v92
    v_exp_f32 v93, v93
    s_cbranch_vccnz L_KV_8
    buffer_load_dwordx4 a[88:91], v5, s[68:71], s97 offen offset:2048 sc1
    buffer_load_dwordx4 a[92:95], v5, s[68:71], s97 offen offset:3072 sc1
L_KV_8:
    v_exp_f32 v94, v94
    v_exp_f32 v95, v95
    v_exp_f32 v96, v96
    v_exp_f32 v97, v97
    s_waitcnt vmcnt(12)
    v_smfmac_f32_32x32x32_bf16 v[32:47], a[12:15], v[88:95], v4
    v_exp_f32 v98, v98
    s_cbranch_vccnz L_KV_9
    buffer_load_dwordx4 a[40:43], v19, s[68:71], s100 offen offset:2048 sc1
    buffer_load_dwordx4 a[44:47], v19, s[68:71], s100 offen offset:3072 sc1
L_KV_9:
    v_exp_f32 v99, v99
    v_exp_f32 v100, v100
    s_waitcnt vmcnt(13)
    v_mfma_f32_32x32x4_2b_bf16 v[64:95], a[100:101], v[24:25], 0
    v_exp_f32 v101, v101
    v_exp_f32 v102, v102
    v_exp_f32 v103, v103
    s_cbranch_vccnz L_KV_10
    buffer_load_dwordx4 a[48:51], v19, s[68:71], s101 offen offset:0 sc1
    buffer_load_dwordx4 a[52:55], v19, s[68:71], s101 offen offset:1024 sc1
L_KV_10:
    v_exp_f32 v104, v104
    v_exp_f32 v105, v105
    v_exp_f32 v106, v106
    v_exp_f32 v107, v107
    v_exp_f32 v108, v108
    s_cbranch_vccnz L_KV_11
    buffer_load_dwordx4 a[56:59], v19, s[68:71], s101 offen offset:2048 sc1
    buffer_load_dwordx4 a[60:63], v19, s[68:71], s101 offen offset:3072 sc1
L_KV_11:
    s_waitcnt vmcnt(16)
    v_smfmac_f32_32x32x32_bf16 v[32:47], a[16:19], v[96:103], v4
    v_exp_f32 v109, v109
    v_exp_f32 v110, v110
    v_exp_f32 v111, v111
    v_exp_f32 v112, v112
    v_exp_f32 v113, v113
    s_waitcnt vmcnt(15)
    v_smfmac_f32_32x32x32_bf16 v[32:47], a[20:23], v[104:111], v4
    v_exp_f32 v114, v114
    v_exp_f32 v115, v115
    v_exp_f32 v116, v116
    s_waitcnt vmcnt(14)
    v_mfma_f32_32x32x16_bf16 v[64:79], a[80:83], v[20:23], v[64:79]
    v_exp_f32 v117, v117
    v_exp_f32 v118, v118
    v_exp_f32 v119, v119
    v_exp_f32 v120, v120
    s_waitcnt vmcnt(13)
    v_mfma_f32_32x32x16_bf16 v[80:95], a[84:87], v[20:23], v[80:95]
    v_exp_f32 v121, v121
    v_exp_f32 v122, v122
    v_exp_f32 v123, v123
    s_waitcnt vmcnt(12)
    v_smfmac_f32_32x32x32_bf16 v[32:47], a[24:27], v[112:119], v4
    v_exp_f32 v124, v124
    v_exp_f32 v125, v125
    v_exp_f32 v126, v126
    v_exp_f32 v127, v127
    v_exp_f32 v64, v64
    v_exp_f32 v65, v65
    s_waitcnt vmcnt(11)
    v_smfmac_f32_32x32x32_bf16 v[32:47], a[28:31], v[120:127], v4
    v_exp_f32 v66, v66
    v_exp_f32 v67, v67
    v_exp_f32 v68, v68
    s_waitcnt vmcnt(10)
    v_mfma_f32_32x32x4_2b_bf16 v[96:127], a[102:103], v[24:25], 0
    v_exp_f32 v69, v69
    v_exp_f32 v70, v70
    v_exp_f32 v71, v71
    v_exp_f32 v72, v72
    v_exp_f32 v73, v73
    v_exp_f32 v74, v74
    v_exp_f32 v75, v75
    v_exp_f32 v76, v76
    s_waitcnt vmcnt(9)
    v_smfmac_f32_32x32x32_bf16 v[32:47], a[32:35], v[64:71], v4
    s_cmp_eq_u32 s93, 0
    s_cbranch_scc1 L_NOB4
    s_waitcnt lgkmcnt(0)
    s_barrier
    ds_read_b64 v[12:13], v11
L_NOB4:
    s_and_b32 s84, s90, 7
    s_mul_i32 s84, s84, 1280
    v_add_u32 v16, s84, v9
    v_add_u32 v1, s84, v10
    s_add_u32 s90, s90, 1
    v_exp_f32 v77, v77
    v_exp_f32 v78, v78
    ds_read_b128 v[26:29], v16
    ds_read_b64 v[30:31], v1
    v_exp_f32 v79, v79
    v_exp_f32 v80, v80
    v_exp_f32 v81, v81
    s_waitcnt vmcnt(8)
    v_smfmac_f32_32x32x32_bf16 v[32:47], a[36:39], v[72:79], v4
    v_exp_f32 v82, v82
    v_exp_f32 v83, v83
    v_exp_f32 v84, v84
    s_waitcnt vmcnt(7)
    v_mfma_f32_32x32x16_bf16 v[96:111], a[88:91], v[20:23], v[96:111]
    v_exp_f32 v85, v85
    v_exp_f32 v86, v86
    v_exp_f32 v87, v87
    v_exp_f32 v88, v88
    s_waitcnt vmcnt(6)
    v_mfma_f32_32x32x16_bf16 v[112:127], a[92:95], v[20:23], v[112:127]
    v_exp_f32 v89, v89
    v_exp_f32 v90, v90
    v_exp_f32 v91, v91
    s_waitcnt vmcnt(5)
    v_smfmac_f32_32x32x32_bf16 v[32:47], a[40:43], v[80:87], v4
    v_exp_f32 v92, v92
    v_exp_f32 v93, v93
    v_exp_f32 v94, v94
    v_exp_f32 v95, v95
    v_exp_f32 v96, v96
    v_exp_f32 v97, v97
    s_waitcnt vmcnt(4)
    v_smfmac_f32_32x32x32_bf16 v[32:47], a[44:47], v[88:95], v4
    s_waitcnt lgkmcnt(0)
    s_cmp_eq_u32 s93, 0
    s_cbranch_scc1 L_NOCK
    v_sqrt_f32 v12, v12
    s_mov_b32 s84, 0x42400000
    v_mul_f32 v13, v13, v12
    v_cmp_nge_f32 s[84:85], s84, v13
    s_nop 0
    s_cmp_lg_u64 s[84:85], 0
    s_cbranch_scc1 L_SLOW
L_NOCK:
    v_exp_f32 v98, v98
    v_exp_f32 v99, v99
    v_exp_f32 v100, v100
    v_mfma_f32_32x32x4_2b_bf16 v[64:95], a[96:97], v[30:31], 0
    v_exp_f32 v101, v101
    v_exp_f32 v102, v102
    v_exp_f32 v103, v103
    v_exp_f32 v104, v104
    v_exp_f32 v105, v105
    v_exp_f32 v106, v106
    v_exp_f32 v107, v107
    v_exp_f32 v108, v108
    s_waitcnt vmcnt(7)
    s_cbranch_vccnz L_VW_12
    s_waitcnt vmcnt(3)
L_VW_12:
    v_smfmac_f32_32x32x32_bf16 v[32:47], a[48:51], v[96:103], v4
    v_exp_f32 v109, v109
    v_exp_f32 v110, v110
    v_exp_f32 v111, v111
    v_exp_f32 v112, v112
    v_exp_f32 v113, v113
    s_waitcnt vmcnt(6)
    s_cbranch_vccnz L_VW_13
    s_waitcnt vmcnt(2)
L_VW_13:
    v_smfmac_f32_32x32x32_bf16 v[32:47], a[52:55], v[104:111], v4
    v_exp_f32 v114, v114
    v_exp_f32 v115, v115
    v_exp_f32 v116, v116
    v_mfma_f32_32x32x16_bf16 v[64:79], a[64:67], v[26:29], v[64:79]
    v_exp_f32 v117, v117
    v_exp_f32 v118, v118
    v_exp_f32 v119, v119
    v_exp_f32 v120, v120
    v_mfma_f32_32x32x16_bf16 v[80:95], a[68:71], v[26:29], v[80:95]
    v_exp_f32 v121, v121
    v_exp_f32 v122, v122
    v_exp_f32 v123, v123
    s_waitcnt vmcnt(5)
    s_cbranch_vccnz L_VW_14
    s_waitcnt vmcnt(1)
L_VW_14:
    v_smfmac_f32_32x32x32_bf16 v[32:47], a[56:59], v[112:119], v4
    v_exp_f32 v124, v124
    v_exp_f32 v125, v125
    v_exp_f32 v126, v126
    v_exp_f32 v127, v127
    v_exp_f32 v64, v64
    v_exp_f32 v65, v65
    s_waitcnt vmcnt(4)
    s_cbranch_vccnz L_VW_15
    s_waitcnt vmcnt(0)
L_VW_15:
    v_smfmac_f32_32x32x32_bf16 v[32:47], a[60:63], v[120:127], v4
    v_exp_f32 v66, v66
    v_exp_f32 v67, v67
    v_exp_f32 v68, v68
    v_mfma_f32_32x32x4_2b_bf16 v[96:127], a[98:99], v[30:31], 0
    v_exp_f32 v69, v69
    v_exp_f32 v70, v70
    v_exp_f32 v71, v71
    v_exp_f32 v72, v72
    v_exp_f32 v73, v73
    v_exp_f32 v74, v74
    v_exp_f32 v75, v75
    v_exp_f32 v76, v76
    v_smfmac_f32_32x32x32_bf16 v[48:63], a[0:3], v[64:71], v4
    v_exp_f32 v77, v77
    v_exp_f32 v78, v78
    ds_write_b128 v7, v[32:35]
    v_exp_f32 v79, v79
    v_exp_f32 v80, v80
    v_exp_f32 v81, v81
    v_smfmac_f32_32x32x32_bf16 v[48:63], a[4:7], v[72:79], v4
    v_exp_f32 v82, v82
    v_exp_f32 v83, v83
    ds_write_b128 v7, v[36:39] offset:1024
    v_cndmask_b32 v41, v41, 1.0, s[86:87]
    v_exp_f32 v84, v84
    v_mfma_f32_32x32x16_bf16 v[96:111], a[72:75], v[26:29], v[96:111]
    v_exp_f32 v85, v85
    v_exp_f32 v86, v86
    ds_write_b64 v7, v[40:41] offset:2048
    v_exp_f32 v87, v87
    v_exp_f32 v88, v88
    v_mfma_f32_32x32x16_bf16 v[112:127], a[76:79], v[26:29], v[112:127]
    v_exp_f32 v89, v89
    v_exp_f32 v90, v90
    v_exp_f32 v91, v91
    v_smfmac_f32_32x32x32_bf16 v[48:63], a[8:11], v[80:87], v4
    v_exp_f32 v92, v92
    v_exp_f32 v93, v93
    v_exp_f32 v94, v94
    v_exp_f32 v95, v95
    v_exp_f32 v96, v96
    v_exp_f32 v97, v97
    v_smfmac_f32_32x32x32_bf16 v[48:63], a[12:15], v[88:95], v4
    v_exp_f32 v98, v98
    v_exp_f32 v99, v99
    v_exp_f32 v100, v100
    v_mfma_f32_32x32x4_2b_bf16 v[64:95], a[100:101], v[30:31], 0
    v_exp_f32 v101, v101
    v_exp_f32 v102, v102
    v_exp_f32 v103, v103
    v_exp_f32 v104, v104
    v_exp_f32 v105, v105
    v_exp_f32 v106, v106
    v_exp_f32 v107, v107
    v_exp_f32 v108, v108
    v_smfmac_f32_32x32x32_bf16 v[48:63], a[16:19], v[96:103], v4
    s_and_b32 s84, s90, 7
    s_mul_i32 s84, s84, 1280
    v_add_u32 v16, s84, v9
    v_add_u32 v1, s84, v10
    s_add_u32 s90, s90, 1
    v_exp_f32 v109, v109
    v_exp_f32 v110, v110
    ds_read_b128 v[20:23], v16
    ds_read_b64 v[24:25], v1
    v_exp_f32 v111, v111
    v_exp_f32 v112, v112
    v_exp_f32 v113, v113
    v_smfmac_f32_32x32x32_bf16 v[48:63], a[20:23], v[104:111], v4
    v_exp_f32 v114, v114
    v_exp_f32 v115, v115
    v_exp_f32 v116, v116
    v_mfma_f32_32x32x16_bf16 v[64:79], a[80:83], v[26:29], v[64:79]
    v_exp_f32 v117, v117
    v_exp_f32 v118, v118
    v_exp_f32 v119, v119
    v_exp_f32 v120, v120
    v_mfma_f32_32x32x16_bf16 v[80:95], a[84:87], v[26:29], v[80:95]
    v_exp_f32 v121, v121
    v_exp_f32 v122, v122
    v_exp_f32 v123, v123
    v_smfmac_f32_32x32x32_bf16 v[48:63], a[24:27], v[112:119], v4
    v_exp_f32 v124, v124
    v_exp_f32 v125, v125
    v_exp_f32 v126, v126
    v_exp_f32 v127, v127
    v_exp_f32 v64, v64
    v_exp_f32 v65, v65
    v_smfmac_f32_32x32x32_bf16 v[48:63], a[28:31], v[120:127], v4
    v_exp_f32 v66, v66
    v_exp_f32 v67, v67
    v_exp_f32 v68, v68
    v_mfma_f32_32x32x4_2b_bf16 v[96:127], a[102:103], v[30:31], 0
    v_exp_f32 v69, v69
    v_exp_f32 v70, v70
    v_exp_f32 v71, v71
    v_exp_f32 v72, v72
    v_exp_f32 v73, v73
    v_exp_f32 v74, v74
    v_exp_f32 v75, v75
    v_exp_f32 v76, v76
    v_smfmac_f32_32x32x32_bf16 v[48:63], a[32:35], v[64:71], v4
    v_exp_f32 v77, v77
    v_exp_f32 v78, v78
    v_exp_f32 v79, v79
    v_exp_f32 v80, v80
    v_exp_f32 v81, v81
    v_smfmac_f32_32x32x32_bf16 v[48:63], a[36:39], v[72:79], v4
    v_exp_f32 v82, v82
    v_exp_f32 v83, v83
    v_exp_f32 v84, v84
    v_mfma_f32_32x32x16_bf16 v[96:111], a[88:91], v[26:29], v[96:111]
    v_exp_f32 v85, v85
    v_exp_f32 v86, v86
    v_exp_f32 v87, v87
    v_exp_f32 v88, v88
    v_mfma_f32_32x32x16_bf16 v[112:127], a[92:95], v[26:29], v[112:127]
    v_exp_f32 v89, v89
    v_exp_f32 v90, v90
    v_exp_f32 v91, v91
    v_smfmac_f32_32x32x32_bf16 v[48:63], a[40:43], v[80:87], v4
    v_exp_f32 v92, v92
    v_exp_f32 v93, v93
    v_exp_f32 v94, v94
    v_exp_f32 v95, v95
    v_exp_f32 v96, v96
    v_exp_f32 v97, v97
    v_smfmac_f32_32x32x32_bf16 v[48:63], a[44:47], v[88:95], v4
    s_waitcnt lgkmcnt(0)
    v_exp_f32 v98, v98
    v_exp_f32 v99, v99
    v_exp_f32 v100, v100
    v_mfma_f32_32x32x4_2b_bf16 v[64:95], a[96:97], v[24:25], 0
    v_exp_f32 v101, v101
    v_exp_f32 v102, v102
    v_exp_f32 v103, v103
    v_exp_f32 v104, v104
    v_exp_f32 v105, v105
    v_exp_f32 v106, v106
    v_exp_f32 v107, v107
    v_exp_f32 v108, v108
    v_smfmac_f32_32x32x32_bf16 v[48:63], a[48:51], v[96:103], v4
    s_and_b32 s84, s91, 7
    s_mul_i32 s84, s84, 3072
    v_add_u32 v7, s84, v17
    s_add_u32 s91, s91, 2
    v_exp_f32 v109, v109
    v_exp_f32 v110, v110
    ds_read_b64 v[40:41], v7 offset:2048
    ds_read_b128 v[32:35], v7
    ds_read_b128 v[36:39], v7 offset:1024
    v_exp_f32 v111, v111
    v_exp_f32 v112, v112
    v_exp_f32 v113, v113
    v_smfmac_f32_32x32x32_bf16 v[48:63], a[52:55], v[104:111], v4
    v_exp_f32 v114, v114
    v_exp_f32 v115, v115
    v_exp_f32 v116, v116
    v_mfma_f32_32x32x16_bf16 v[64:79], a[64:67], v[20:23], v[64:79]
    v_exp_f32 v117, v117
    v_exp_f32 v118, v118
    v_exp_f32 v119, v119
    v_exp_f32 v120, v120
    v_mfma_f32_32x32x16_bf16 v[80:95], a[68:71], v[20:23], v[80:95]
    v_exp_f32 v121, v121
    v_exp_f32 v122, v122
    v_exp_f32 v123, v123
    v_smfmac_f32_32x32x32_bf16 v[48:63], a[56:59], v[112:119], v4
    v_exp_f32 v124, v124
    v_exp_f32 v125, v125
    v_exp_f32 v126, v126
    v_exp_f32 v127, v127
    v_exp_f32 v64, v64
    v_exp_f32 v65, v65
    v_smfmac_f32_32x32x32_bf16 v[48:63], a[60:63], v[120:127], v4
    v_exp_f32 v66, v66
    v_exp_f32 v67, v67
    v_exp_f32 v68, v68
    v_mfma_f32_32x32x4_2b_bf16 v[96:127], a[98:99], v[24:25], 0
    v_exp_f32 v69, v69
    v_exp_f32 v70, v70
    v_exp_f32 v71, v71
    v_exp_f32 v72, v72
    v_exp_f32 v73, v73
    v_exp_f32 v74, v74
    s_waitcnt lgkmcnt(0)
    v_cmp_neq_f32 vcc, 1.0, v41
    v_exp_f32 v75, v75
    s_cmp_lg_u32 vcc_hi, 0
    s_cbranch_scc1 L_RT1
L_RT1B:
    v_exp_f32 v76, v76
    v_smfmac_f32_32x32x32_bf16 v[32:47], a[0:3], v[64:71], v4
    v_exp_f32 v77, v77
    v_exp_f32 v78, v78
    ds_write_b128 v7, v[48:51]
    v_exp_f32 v79, v79
    v_exp_f32 v80, v80
    v_exp_f32 v81, v81
    v_smfmac_f32_32x32x32_bf16 v[32:47], a[4:7], v[72:79], v4
    v_exp_f32 v82, v82
    v_exp_f32 v83, v83
    ds_write_b128 v7, v[52:55] offset:1024
    v_cndmask_b32 v57, v57, 2.0, s[86:87]
    v_exp_f32 v84, v84
    v_mfma_f32_32x32x16_bf16 v[96:111], a[72:75], v[20:23], v[96:111]
    v_exp_f32 v85, v85
    v_exp_f32 v86, v86
    ds_write_b64 v7, v[56:57] offset:2048
    v_exp_f32 v87, v87
    v_exp_f32 v88, v88
    v_mfma_f32_32x32x16_bf16 v[112:127], a[76:79], v[20:23], v[112:127]
    v_exp_f32 v89, v89
    v_exp_f32 v90, v90
    v_exp_f32 v91, v91
    v_smfmac_f32_32x32x32_bf16 v[32:47], a[8:11], v[80:87], v4
    v_exp_f32 v92, v92
    v_exp_f32 v93, v93
    v_exp_f32 v94, v94
    v_exp_f32 v95, v95
    v_exp_f32 v96, v96
    v_exp_f32 v97, v97
    v_smfmac_f32_32x32x32_bf16 v[32:47], a[12:15], v[88:95], v4
    v_exp_f32 v98, v98
    v_exp_f32 v99, v99
    v_exp_f32 v100, v100
    v_mfma_f32_32x32x4_2b_bf16 v[64:95], a[100:101], v[24:25], 0
    v_exp_f32 v101, v101
    v_exp_f32 v102, v102
    v_exp_f32 v103, v103
    v_exp_f32 v104, v104
    v_exp_f32 v105, v105
    v_exp_f32 v106, v106
    v_exp_f32 v107, v107
    v_exp_f32 v108, v108
    v_smfmac_f32_32x32x32_bf16 v[32:47], a[16:19], v[96:103], v4
    s_and_b32 s84, s90, 7
    s_mul_i32 s84, s84, 1280
    v_add_u32 v16, s84, v9
    v_add_u32 v1, s84, v10
    s_add_u32 s90, s90, 1
    v_exp_f32 v109, v109
    v_exp_f32 v110, v110
    ds_read_b128 v[26:29], v16
    ds_read_b64 v[30:31], v1
    v_exp_f32 v111, v111
    v_exp_f32 v112, v112
    v_exp_f32 v113, v113
    v_smfmac_f32_32x32x32_bf16 v[32:47], a[20:23], v[104:111], v4
    v_exp_f32 v114, v114
    v_exp_f32 v115, v115
    v_exp_f32 v116, v116
    v_mfma_f32_32x32x16_bf16 v[64:79], a[80:83], v[20:23], v[64:79]
    v_exp_f32 v117, v117
    v_exp_f32 v118, v118
    v_exp_f32 v119, v119
    v_exp_f32 v120, v120
    v_mfma_f32_32x32x16_bf16 v[80:95], a[84:87], v[20:23], v[80:95]
    v_exp_f32 v121, v121
    v_exp_f32 v122, v122
    v_exp_f32 v123, v123
    v_smfmac_f32_32x32x32_bf16 v[32:47], a[24:27], v[112:119], v4
    v_exp_f32 v124, v124
    v_exp_f32 v125, v125
    v_exp_f32 v126, v126
    v_exp_f32 v127, v127
    v_exp_f32 v64, v64
    v_exp_f32 v65, v65
    v_smfmac_f32_32x32x32_bf16 v[32:47], a[28:31], v[120:127], v4
    v_exp_f32 v66, v66
    v_exp_f32 v67, v67
    v_exp_f32 v68, v68
    v_mfma_f32_32x32x4_2b_bf16 v[96:127], a[102:103], v[24:25], 0
    v_exp_f32 v69, v69
    v_exp_f32 v70, v70
    v_exp_f32 v71, v71
    v_exp_f32 v72, v72
    v_exp_f32 v73, v73
    v_exp_f32 v74, v74
    v_exp_f32 v75, v75
    v_exp_f32 v76, v76
    v_smfmac_f32_32x32x32_bf16 v[32:47], a[32:35], v[64:71], v4
    v_exp_f32 v77, v77
    v_exp_f32 v78, v78
    v_exp_f32 v79, v79
    v_exp_f32 v80, v80
    v_exp_f32 v81, v81
    v_smfmac_f32_32x32x32_bf16 v[32:47], a[36:39], v[72:79], v4
    v_exp_f32 v82, v82
    v_exp_f32 v83, v83
    v_exp_f32 v84, v84
    v_mfma_f32_32x32x16_bf16 v[96:111], a[88:91], v[20:23], v[96:111]
    v_exp_f32 v85, v85
    v_exp_f32 v86, v86
    v_exp_f32 v87, v87
    v_exp_f32 v88, v88
    v_mfma_f32_32x32x16_bf16 v[112:127], a[92:95], v[20:23], v[112:127]
    v_exp_f32 v89, v89
    v_exp_f32 v90, v90
    v_exp_f32 v91, v91
    v_smfmac_f32_32x32x32_bf16 v[32:47], a[40:43], v[80:87], v4
    v_exp_f32 v92, v92
    v_exp_f32 v93, v93
    v_exp_f32 v94, v94
    v_exp_f32 v95, v95
    v_exp_f32 v96, v96
    v_exp_f32 v97, v97
    v_smfmac_f32_32x32x32_bf16 v[32:47], a[44:47], v[88:95], v4
    s_waitcnt lgkmcnt(0)
    v_exp_f32 v98, v98
    v_exp_f32 v99, v99
    v_exp_f32 v100, v100
    v_mfma_f32_32x32x4_2b_bf16 v[64:95], a[96:97], v[30:31], 0
    v_exp_f32 v101, v101
    v_exp_f32 v102, v102
    v_exp_f32 v103, v103
    v_exp_f32 v104, v104
    v_exp_f32 v105, v105
    v_exp_f32 v106, v106
    v_exp_f32 v107, v107
    v_exp_f32 v108, v108
    v_smfmac_f32_32x32x32_bf16 v[32:47], a[48:51], v[96:103], v4
    s_and_b32 s84, s91, 7
    s_mul_i32 s84, s84, 3072
    v_add_u32 v7, s84, v17
    s_add_u32 s91, s91, 2
    v_exp_f32 v109, v109
    v_exp_f32 v110, v110
    ds_read_b64 v[56:57], v7 offset:2048
    ds_read_b128 v[48:51], v7
    ds_read_b128 v[52:55], v7 offset:1024
    v_exp_f32 v111, v111
    v_exp_f32 v112, v112
    v_exp_f32 v113, v113
    v_smfmac_f32_32x32x32_bf16 v[32:47], a[52:55], v[104:111], v4
    v_exp_f32 v114, v114
    v_exp_f32 v115, v115
    v_exp_f32 v116, v116
    v_mfma_f32_32x32x16_bf16 v[64:79], a[64:67], v[26:29], v[64:79]
    v_exp_f32 v117, v117
    v_exp_f32 v118, v118
    v_exp_f32 v119, v119
    v_exp_f32 v120, v120
    v_mfma_f32_32x32x16_bf16 v[80:95], a[68:71], v[26:29], v[80:95]
    v_exp_f32 v121, v121
    v_exp_f32 v122, v122
    v_exp_f32 v123, v123
    v_smfmac_f32_32x32x32_bf16 v[32:47], a[56:59], v[112:119], v4
    v_exp_f32 v124, v124
    v_exp_f32 v125, v125
    v_exp_f32 v126, v126
    v_exp_f32 v127, v127
    v_exp_f32 v64, v64
    v_exp_f32 v65, v65
    v_smfmac_f32_32x32x32_bf16 v[32:47], a[60:63], v[120:127], v4
    v_exp_f32 v66, v66
    v_exp_f32 v67, v67
    v_exp_f32 v68, v68
    v_mfma_f32_32x32x4_2b_bf16 v[96:127], a[98:99], v[30:31], 0
    v_exp_f32 v69, v69
    v_exp_f32 v70, v70
    v_exp_f32 v71, v71
    v_exp_f32 v72, v72
    v_exp_f32 v73, v73
    v_exp_f32 v74, v74
    s_waitcnt lgkmcnt(0)
    v_cmp_neq_f32 vcc, 2.0, v57
    v_exp_f32 v75, v75
    s_cmp_lg_u32 vcc_hi, 0
    s_cbranch_scc1 L_RT2
L_RT2B:
    v_exp_f32 v76, v76
    v_smfmac_f32_32x32x32_bf16 v[48:63], a[0:3], v[64:71], v4
    v_exp_f32 v77, v77
    v_exp_f32 v78, v78
    ds_write_b128 v7, v[32:35]
    v_exp_f32 v79, v79
    v_exp_f32 v80, v80
    v_exp_f32 v81, v81
    v_smfmac_f32_32x32x32_bf16 v[48:63], a[4:7], v[72:79], v4
    v_exp_f32 v82, v82
    v_exp_f32 v83, v83
    ds_write_b128 v7, v[36:39] offset:1024
    v_cndmask_b32 v41, v41, 4.0, s[86:87]
    v_exp_f32 v84, v84
    v_mfma_f32_32x32x16_bf16 v[96:111], a[72:75], v[26:29], v[96:111]
    v_exp_f32 v85, v85
    v_exp_f32 v86, v86
    ds_write_b64 v7, v[40:41] offset:2048
    v_exp_f32 v87, v87
    v_exp_f32 v88, v88
    v_mfma_f32_32x32x16_bf16 v[112:127], a[76:79], v[26:29], v[112:127]
    v_exp_f32 v89, v89
    v_exp_f32 v90, v90
    v_exp_f32 v91, v91
    v_smfmac_f32_32x32x32_bf16 v[48:63], a[8:11], v[80:87], v4
    v_exp_f32 v92, v92
    v_exp_f32 v93, v93
    v_exp_f32 v94, v94
    v_exp_f32 v95, v95
    v_exp_f32 v96, v96
    v_exp_f32 v97, v97
    v_smfmac_f32_32x32x32_bf16 v[48:63], a[12:15], v[88:95], v4
    v_exp_f32 v98, v98
    v_exp_f32 v99, v99
    v_exp_f32 v100, v100
    v_mfma_f32_32x32x4_2b_bf16 v[64:95], a[100:101], v[30:31], 0
    v_exp_f32 v101, v101
    v_exp_f32 v102, v102
    v_exp_f32 v103, v103
    v_exp_f32 v104, v104
    v_exp_f32 v105, v105
    v_exp_f32 v106, v106
    v_exp_f32 v107, v107
    v_exp_f32 v108, v108
    v_smfmac_f32_32x32x32_bf16 v[48:63], a[16:19], v[96:103], v4
    s_and_b32 s84, s90, 7
    s_mul_i32 s84, s84, 1280
    v_add_u32 v16, s84, v9
    v_add_u32 v1, s84, v10
    s_add_u32 s90, s90, 1
    v_exp_f32 v109, v109
    v_exp_f32 v110, v110
    ds_read_b128 v[20:23], v16
    ds_read_b64 v[24:25], v1
    v_exp_f32 v111, v111
    v_exp_f32 v112, v112
    v_exp_f32 v113, v113
    v_smfmac_f32_32x32x32_bf16 v[48:63], a[20:23], v[104:111], v4
    v_exp_f32 v114, v114
    v_exp_f32 v115, v115
    v_exp_f32 v116, v116
    v_mfma_f32_32x32x16_bf16 v[64:79], a[80:83], v[26:29], v[64:79]
    v_exp_f32 v117, v117
    v_exp_f32 v118, v118
    v_exp_f32 v119, v119
    v_exp_f32 v120, v120
    v_mfma_f32_32x32x16_bf16 v[80:95], a[84:87], v[26:29], v[80:95]
    v_exp_f32 v121, v121
    v_exp_f32 v122, v122
    v_exp_f32 v123, v123
    v_smfmac_f32_32x32x32_bf16 v[48:63], a[24:27], v[112:119], v4
    v_exp_f32 v124, v124
    v_exp_f32 v125, v125
    v_exp_f32 v126, v126
    v_exp_f32 v127, v127
    v_exp_f32 v64, v64
    v_exp_f32 v65, v65
    v_smfmac_f32_32x32x32_bf16 v[48:63], a[28:31], v[120:127], v4
    v_exp_f32 v66, v66
    v_exp_f32 v67, v67
    v_exp_f32 v68, v68
    v_mfma_f32_32x32x4_2b_bf16 v[96:127], a[102:103], v[30:31], 0
    v_exp_f32 v69, v69
    v_exp_f32 v70, v70
    v_exp_f32 v71, v71
    v_exp_f32 v72, v72
    v_exp_f32 v73, v73
    v_exp_f32 v74, v74
    v_exp_f32 v75, v75
    v_exp_f32 v76, v76
    v_smfmac_f32_32x32x32_bf16 v[48:63], a[32:35], v[64:71], v4
    v_exp_f32 v77, v77
    v_exp_f32 v78, v78
    v_exp_f32 v79, v79
    v_exp_f32 v80, v80
    v_exp_f32 v81, v81
    v_smfmac_f32_32x32x32_bf16 v[48:63], a[36:39], v[72:79], v4
    v_exp_f32 v82, v82
    v_exp_f32 v83, v83
    v_exp_f32 v84, v84
    v_mfma_f32_32x32x16_bf16 v[96:111], a[88:91], v[26:29], v[96:111]
    v_exp_f32 v85, v85
    v_exp_f32 v86, v86
    v_exp_f32 v87, v87
    v_exp_f32 v88, v88
    v_mfma_f32_32x32x16_bf16 v[112:127], a[92:95], v[26:29], v[112:127]
    v_exp_f32 v89, v89
    v_exp_f32 v90, v90
    v_exp_f32 v91, v91
    v_smfmac_f32_32x32x32_bf16 v[48:63], a[40:43], v[80:87], v4
    v_exp_f32 v92, v92
    v_exp_f32 v93, v93
    v_exp_f32 v94, v94
    v_exp_f32 v95, v95
    v_exp_f32 v96, v96
    v_exp_f32 v97, v97
    v_smfmac_f32_32x32x32_bf16 v[48:63], a[44:47], v[88:95], v4
    s_waitcnt lgkmcnt(0)
    v_exp_f32 v98, v98
    v_exp_f32 v99, v99
    v_exp_f32 v100, v100
    v_mfma_f32_32x32x4_2b_bf16 v[64:95], a[96:97], v[24:25], 0
    v_exp_f32 v101, v101
    v_exp_f32 v102, v102
    v_exp_f32 v103, v103
    v_exp_f32 v104, v104
    v_exp_f32 v105, v105
    v_exp_f32 v106, v106
    v_exp_f32 v107, v107
    v_exp_f32 v108, v108
    v_smfmac_f32_32x32x32_bf16 v[48:63], a[48:51], v[96:103], v4
    s_and_b32 s84, s91, 7
    s_mul_i32 s84, s84, 3072
    v_add_u32 v7, s84, v17
    s_add_u32 s91, s91, 2
    v_exp_f32 v109, v109
    v_exp_f32 v110, v110
    ds_read_b64 v[40:41], v7 offset:2048
    ds_read_b128 v[32:35], v7
    ds_read_b128 v[36:39], v7 offset:1024
    v_exp_f32 v111, v111
    v_exp_f32 v112, v112
    v_exp_f32 v113, v113
    v_smfmac_f32_32x32x32_bf16 v[48:63], a[52:55], v[104:111], v4
    v_exp_f32 v114, v114
    v_exp_f32 v115, v115
    v_exp_f32 v116, v116
    v_mfma_f32_32x32x16_bf16 v[64:79], a[64:67], v[20:23], v[64:79]
    v_exp_f32 v117, v117
    v_exp_f32 v118, v118
    v_exp_f32 v119, v119
    v_exp_f32 v120, v120
    v_mfma_f32_32x32x16_bf16 v[80:95], a[68:71], v[20:23], v[80:95]
    v_exp_f32 v121, v121
    v_exp_f32 v122, v122
    v_exp_f32 v123, v123
    v_smfmac_f32_32x32x32_bf16 v[48:63], a[56:59], v[112:119], v4
    v_exp_f32 v124, v124
    v_exp_f32 v125, v125
    v_exp_f32 v126, v126
    v_exp_f32 v127, v127
    v_exp_f32 v64, v64
    v_exp_f32 v65, v65
    v_smfmac_f32_32x32x32_bf16 v[48:63], a[60:63], v[120:127], v4
    v_exp_f32 v66, v66
    v_exp_f32 v67, v67
    v_exp_f32 v68, v68
    v_mfma_f32_32x32x4_2b_bf16 v[96:127], a[98:99], v[24:25], 0
    v_exp_f32 v69, v69
    v_exp_f32 v70, v70
    v_exp_f32 v71, v71
    v_exp_f32 v72, v72
    v_exp_f32 v73, v73
    v_exp_f32 v74, v74
    s_waitcnt lgkmcnt(0)
    v_cmp_neq_f32 vcc, 4.0, v41
    v_exp_f32 v75, v75
    s_cmp_lg_u32 vcc_hi, 0
    s_cbranch_scc1 L_RT3
L_RT3B:
    v_exp_f32 v76, v76
    v_smfmac_f32_32x32x32_bf16 v[32:47], a[0:3], v[64:71], v4
    v_exp_f32 v77, v77
    v_exp_f32 v78, v78
    ds_write_b128 v7, v[48:51]
    v_exp_f32 v79, v79
    v_exp_f32 v80, v80
    v_exp_f32 v81, v81
    v_smfmac_f32_32x32x32_bf16 v[32:47], a[4:7], v[72:79], v4
    v_exp_f32 v82, v82
    v_exp_f32 v83, v83
    ds_write_b128 v7, v[52:55] offset:1024
    v_cndmask_b32 v57, v57, 0.5, s[86:87]
    v_exp_f32 v84, v84
    v_mfma_f32_32x32x16_bf16 v[96:111], a[72:75], v[20:23], v[96:111]
    v_exp_f32 v85, v85
    v_exp_f32 v86, v86
    ds_write_b64 v7, v[56:57] offset:2048
    v_exp_f32 v87, v87
    v_exp_f32 v88, v88
    v_mfma_f32_32x32x16_bf16 v[112:127], a[76:79], v[20:23], v[112:127]
    v_exp_f32 v89, v89
    v_exp_f32 v90, v90
    v_exp_f32 v91, v91
    v_smfmac_f32_32x32x32_bf16 v[32:47], a[8:11], v[80:87], v4
    v_exp_f32 v92, v92
    v_exp_f32 v93, v93
    v_exp_f32 v94, v94
    v_exp_f32 v95, v95
    v_exp_f32 v96, v96
    v_exp_f32 v97, v97
    v_smfmac_f32_32x32x32_bf16 v[32:47], a[12:15], v[88:95], v4
    v_exp_f32 v98, v98
    v_exp_f32 v99, v99
    v_exp_f32 v100, v100
    v_mfma_f32_32x32x4_2b_bf16 v[64:95], a[100:101], v[24:25], 0
    v_exp_f32 v101, v101
    v_exp_f32 v102, v102
    v_exp_f32 v103, v103
    v_exp_f32 v104, v104
    v_exp_f32 v105, v105
    v_exp_f32 v106, v106
    v_exp_f32 v107, v107
    v_exp_f32 v108, v108
    v_smfmac_f32_32x32x32_bf16 v[32:47], a[16:19], v[96:103], v4
    s_and_b32 s84, s90, 7
    s_mul_i32 s84, s84, 1280
    v_add_u32 v16, s84, v9
    v_add_u32 v1, s84, v10
    s_add_u32 s90, s90, 1
    v_exp_f32 v109, v109
    v_exp_f32 v110, v110
    ds_read_b128 v[26:29], v16
    ds_read_b64 v[30:31], v1
    v_exp_f32 v111, v111
    v_exp_f32 v112, v112
    v_exp_f32 v113, v113
    v_smfmac_f32_32x32x32_bf16 v[32:47], a[20:23], v[104:111], v4
    v_exp_f32 v114, v114
    v_exp_f32 v115, v115
    v_exp_f32 v116, v116
    v_mfma_f32_32x32x16_bf16 v[64:79], a[80:83], v[20:23], v[64:79]
    v_exp_f32 v117, v117
    v_exp_f32 v118, v118
    v_exp_f32 v119, v119
    v_exp_f32 v120, v120
    v_mfma_f32_32x32x16_bf16 v[80:95], a[84:87], v[20:23], v[80:95]
    v_exp_f32 v121, v121
    v_exp_f32 v122, v122
    v_exp_f32 v123, v123
    v_smfmac_f32_32x32x32_bf16 v[32:47], a[24:27], v[112:119], v4
    v_exp_f32 v124, v124
    v_exp_f32 v125, v125
    v_exp_f32 v126, v126
    v_exp_f32 v127, v127
    v_exp_f32 v64, v64
    v_exp_f32 v65, v65
    v_smfmac_f32_32x32x32_bf16 v[32:47], a[28:31], v[120:127], v4
    v_exp_f32 v66, v66
    v_exp_f32 v67, v67
    v_exp_f32 v68, v68
    v_mfma_f32_32x32x4_2b_bf16 v[96:127], a[102:103], v[24:25], 0
    v_exp_f32 v69, v69
    v_exp_f32 v70, v70
    v_exp_f32 v71, v71
    v_exp_f32 v72, v72
    v_exp_f32 v73, v73
    v_exp_f32 v74, v74
    v_exp_f32 v75, v75
    v_exp_f32 v76, v76
    v_smfmac_f32_32x32x32_bf16 v[32:47], a[32:35], v[64:71], v4
    v_exp_f32 v77, v77
    v_exp_f32 v78, v78
    v_exp_f32 v79, v79
    v_exp_f32 v80, v80
    v_exp_f32 v81, v81
    v_smfmac_f32_32x32x32_bf16 v[32:47], a[36:39], v[72:79], v4
    v_exp_f32 v82, v82
    v_exp_f32 v83, v83
    v_exp_f32 v84, v84
    v_mfma_f32_32x32x16_bf16 v[96:111], a[88:91], v[20:23], v[96:111]
    v_exp_f32 v85, v85
    v_exp_f32 v86, v86
    v_exp_f32 v87, v87
    v_exp_f32 v88, v88
    v_mfma_f32_32x32x16_bf16 v[112:127], a[92:95], v[20:23], v[112:127]
    v_exp_f32 v89, v89
    v_exp_f32 v90, v90
    v_exp_f32 v91, v91
    v_smfmac_f32_32x32x32_bf16 v[32:47], a[40:43], v[80:87], v4
    v_exp_f32 v92, v92
    v_exp_f32 v93, v93
    v_exp_f32 v94, v94
    v_exp_f32 v95, v95
    v_exp_f32 v96, v96
    v_exp_f32 v97, v97
    v_smfmac_f32_32x32x32_bf16 v[32:47], a[44:47], v[88:95], v4
    s_waitcnt lgkmcnt(0)
    v_exp_f32 v98, v98
    v_exp_f32 v99, v99
    v_exp_f32 v100, v100
    v_mfma_f32_32x32x4_2b_bf16 v[64:95], a[96:97], v[30:31], 0
    v_exp_f32 v101, v101
    v_exp_f32 v102, v102
    v_exp_f32 v103, v103
    v_exp_f32 v104, v104
    v_exp_f32 v105, v105
    v_exp_f32 v106, v106
    v_exp_f32 v107, v107
    v_exp_f32 v108, v108
    v_smfmac_f32_32x32x32_bf16 v[32:47], a[48:51], v[96:103], v4
    s_and_b32 s84, s91, 7
    s_mul_i32 s84, s84, 3072
    v_add_u32 v7, s84, v17
    s_add_u32 s91, s91, 2
    v_exp_f32 v109, v109
    v_exp_f32 v110, v110
    ds_read_b64 v[56:57], v7 offset:2048
    ds_read_b128 v[48:51], v7
    ds_read_b128 v[52:55], v7 offset:1024
    v_exp_f32 v111, v111
    v_exp_f32 v112, v112
    v_exp_f32 v113, v113
    v_smfmac_f32_32x32x32_bf16 v[32:47], a[52:55], v[104:111], v4
    v_exp_f32 v114, v114
    v_exp_f32 v115, v115
    v_exp_f32 v116, v116
    v_mfma_f32_32x32x16_bf16 v[64:79], a[64:67], v[26:29], v[64:79]
    v_exp_f32 v117, v117
    v_exp_f32 v118, v118
    v_exp_f32 v119, v119
    v_exp_f32 v120, v120
    v_mfma_f32_32x32x16_bf16 v[80:95], a[68:71], v[26:29], v[80:95]
    v_exp_f32 v121, v121
    v_exp_f32 v122, v122
    v_exp_f32 v123, v123
    v_smfmac_f32_32x32x32_bf16 v[32:47], a[56:59], v[112:119], v4
    v_exp_f32 v124, v124
    v_exp_f32 v125, v125
    v_exp_f32 v126, v126
    v_exp_f32 v127, v127
    v_exp_f32 v64, v64
    v_exp_f32 v65, v65
    v_smfmac_f32_32x32x32_bf16 v[32:47], a[60:63], v[120:127], v4
    v_exp_f32 v66, v66
    v_exp_f32 v67, v67
    v_exp_f32 v68, v68
    v_mfma_f32_32x32x4_2b_bf16 v[96:127], a[98:99], v[30:31], 0
    v_exp_f32 v69, v69
    v_exp_f32 v70, v70
    v_exp_f32 v71, v71
    v_exp_f32 v72, v72
    v_exp_f32 v73, v73
    v_exp_f32 v74, v74
    s_waitcnt lgkmcnt(0)
    v_cmp_neq_f32 vcc, 0.5, v57
    v_exp_f32 v75, v75
    s_cmp_lg_u32 vcc_hi, 0
    s_cbranch_scc1 L_RT4
L_RT4B:
    v_exp_f32 v76, v76
    v_smfmac_f32_32x32x32_bf16 v[48:63], a[0:3], v[64:71], v4
    v_exp_f32 v77, v77
    v_exp_f32 v78, v78
    ds_write_b128 v7, v[32:35]
    v_exp_f32 v79, v79
    v_exp_f32 v80, v80
    v_exp_f32 v81, v81
    v_smfmac_f32_32x32x32_bf16 v[48:63], a[4:7], v[72:79], v4
    v_exp_f32 v82, v82
    v_exp_f32 v83, v83
    ds_write_b128 v7, v[36:39] offset:1024
    v_cndmask_b32 v41, v41, -1.0, s[86:87]
    v_exp_f32 v84, v84
    v_mfma_f32_32x32x16_bf16 v[96:111], a[72:75], v[26:29], v[96:111]
    v_exp_f32 v85, v85
    v_exp_f32 v86, v86
    ds_write_b64 v7, v[40:41] offset:2048
    v_exp_f32 v87, v87
    v_exp_f32 v88, v88
    v_mfma_f32_32x32x16_bf16 v[112:127], a[76:79], v[26:29], v[112:127]
    v_exp_f32 v89, v89
    v_exp_f32 v90, v90
    v_exp_f32 v91, v91
    v_smfmac_f32_32x32x32_bf16 v[48:63], a[8:11], v[80:87], v4
    v_exp_f32 v92, v92
    v_exp_f32 v93, v93
    v_exp_f32 v94, v94
    v_exp_f32 v95, v95
    v_exp_f32 v96, v96
    v_exp_f32 v97, v97
    v_smfmac_f32_32x32x32_bf16 v[48:63], a[12:15], v[88:95], v4
    v_exp_f32 v98, v98
    v_exp_f32 v99, v99
    v_exp_f32 v100, v100
    v_mfma_f32_32x32x4_2b_bf16 v[64:95], a[100:101], v[30:31], 0
    v_exp_f32 v101, v101
    v_exp_f32 v102, v102
    v_exp_f32 v103, v103
    v_exp_f32 v104, v104
    v_exp_f32 v105, v105
    v_exp_f32 v106, v106
    v_exp_f32 v107, v107
    v_exp_f32 v108, v108
    v_smfmac_f32_32x32x32_bf16 v[48:63], a[16:19], v[96:103], v4
    s_and_b32 s84, s90, 7
    s_mul_i32 s84, s84, 1280
    v_add_u32 v16, s84, v9
    v_add_u32 v1, s84, v10
    s_add_u32 s90, s90, 1
    v_exp_f32 v109, v109
    v_exp_f32 v110, v110
    ds_read_b128 v[20:23], v16
    ds_read_b64 v[24:25], v1
    v_exp_f32 v111, v111
    v_exp_f32 v112, v112
    v_exp_f32 v113, v113
    v_smfmac_f32_32x32x32_bf16 v[48:63], a[20:23], v[104:111], v4
    v_exp_f32 v114, v114
    v_exp_f32 v115, v115
    v_exp_f32 v116, v116
    v_mfma_f32_32x32x16_bf16 v[64:79], a[80:83], v[26:29], v[64:79]
    v_exp_f32 v117, v117
    v_exp_f32 v118, v118
    v_exp_f32 v119, v119
    v_exp_f32 v120, v120
    v_mfma_f32_32x32x16_bf16 v[80:95], a[84:87], v[26:29], v[80:95]
    v_exp_f32 v121, v121
    v_exp_f32 v122, v122
    v_exp_f32 v123, v123
    v_smfmac_f32_32x32x32_bf16 v[48:63], a[24:27], v[112:119], v4
    v_exp_f32 v124, v124
    v_exp_f32 v125, v125
    v_exp_f32 v126, v126
    v_exp_f32 v127, v127
    v_exp_f32 v64, v64
    v_exp_f32 v65, v65
    v_smfmac_f32_32x32x32_bf16 v[48:63], a[28:31], v[120:127], v4
    v_exp_f32 v66, v66
    v_exp_f32 v67, v67
    v_exp_f32 v68, v68
    v_mfma_f32_32x32x4_2b_bf16 v[96:127], a[102:103], v[30:31], 0
    v_exp_f32 v69, v69
    v_exp_f32 v70, v70
    v_exp_f32 v71, v71
    v_exp_f32 v72, v72
    v_exp_f32 v73, v73
    v_exp_f32 v74, v74
    v_exp_f32 v75, v75
    v_exp_f32 v76, v76
    v_smfmac_f32_32x32x32_bf16 v[48:63], a[32:35], v[64:71], v4
    v_exp_f32 v77, v77
    v_exp_f32 v78, v78
    v_exp_f32 v79, v79
    v_exp_f32 v80, v80
    v_exp_f32 v81, v81
    v_smfmac_f32_32x32x32_bf16 v[48:63], a[36:39], v[72:79], v4
    v_exp_f32 v82, v82
    v_exp_f32 v83, v83
    v_exp_f32 v84, v84
    v_mfma_f32_32x32x16_bf16 v[96:111], a[88:91], v[26:29], v[96:111]
    v_exp_f32 v85, v85
    v_exp_f32 v86, v86
    v_exp_f32 v87, v87
    v_exp_f32 v88, v88
    v_mfma_f32_32x32x16_bf16 v[112:127], a[92:95], v[26:29], v[112:127]
    v_exp_f32 v89, v89
    v_exp_f32 v90, v90
    v_exp_f32 v91, v91
    v_smfmac_f32_32x32x32_bf16 v[48:63], a[40:43], v[80:87], v4
    v_exp_f32 v92, v92
    v_exp_f32 v93, v93
    v_exp_f32 v94, v94
    v_exp_f32 v95, v95
    v_exp_f32 v96, v96
    v_exp_f32 v97, v97
    v_smfmac_f32_32x32x32_bf16 v[48:63], a[44:47], v[88:95], v4
    s_waitcnt lgkmcnt(0)
    v_exp_f32 v98, v98
    v_exp_f32 v99, v99
    v_exp_f32 v100, v100
    v_mfma_f32_32x32x4_2b_bf16 v[64:95], a[96:97], v[24:25], 0
    v_exp_f32 v101, v101
    v_exp_f32 v102, v102
    v_exp_f32 v103, v103
    v_exp_f32 v104, v104
    v_exp_f32 v105, v105
    v_exp_f32 v106, v106
    v_exp_f32 v107, v107
    v_exp_f32 v108, v108
    v_smfmac_f32_32x32x32_bf16 v[48:63], a[48:51], v[96:103], v4
    s_and_b32 s84, s91, 7
    s_mul_i32 s84, s84, 3072
    v_add_u32 v7, s84, v17
    s_add_u32 s91, s91, 2
    v_exp_f32 v109, v109
    v_exp_f32 v110, v110
    ds_read_b64 v[40:41], v7 offset:2048
    ds_read_b128 v[32:35], v7
    ds_read_b128 v[36:39], v7 offset:1024
    v_exp_f32 v111, v111
    v_exp_f32 v112, v112
    v_exp_f32 v113, v113
    v_smfmac_f32_32x32x32_bf16 v[48:63], a[52:55], v[104:111], v4
    v_exp_f32 v114, v114
    v_exp_f32 v115, v115
    v_exp_f32 v116, v116
    v_mfma_f32_32x32x16_bf16 v[64:79], a[64:67], v[20:23], v[64:79]
    v_exp_f32 v117, v117
    v_exp_f32 v118, v118
    v_exp_f32 v119, v119
    v_exp_f32 v120, v120
    v_mfma_f32_32x32x16_bf16 v[80:95], a[68:71], v[20:23], v[80:95]
    v_exp_f32 v121, v121
    v_exp_f32 v122, v122
    v_exp_f32 v123, v123
    v_smfmac_f32_32x32x32_bf16 v[48:63], a[56:59], v[112:119], v4
    v_exp_f32 v124, v124
    v_exp_f32 v125, v125
    v_exp_f32 v126, v126
    v_exp_f32 v127, v127
    v_exp_f32 v64, v64
    v_exp_f32 v65, v65
    v_smfmac_f32_32x32x32_bf16 v[48:63], a[60:63], v[120:127], v4
    v_exp_f32 v66, v66
    v_exp_f32 v67, v67
    v_exp_f32 v68, v68
    v_mfma_f32_32x32x4_2b_bf16 v[96:127], a[98:99], v[24:25], 0
    v_exp_f32 v69, v69
    v_exp_f32 v70, v70
    v_exp_f32 v71, v71
    v_exp_f32 v72, v72
    v_exp_f32 v73, v73
    v_exp_f32 v74, v74
    s_waitcnt lgkmcnt(0)
    v_cmp_neq_f32 vcc, -1.0, v41
    v_exp_f32 v75, v75
    s_cmp_lg_u32 vcc_hi, 0
    s_cbranch_scc1 L_RT5
L_RT5B:
    v_exp_f32 v76, v76
    v_smfmac_f32_32x32x32_bf16 v[32:47], a[0:3], v[64:71], v4
    v_exp_f32 v77, v77
    v_exp_f32 v78, v78
    ds_write_b128 v7, v[48:51]
    v_exp_f32 v79, v79
    v_exp_f32 v80, v80
    v_exp_f32 v81, v81
    v_smfmac_f32_32x32x32_bf16 v[32:47], a[4:7], v[72:79], v4
    v_exp_f32 v82, v82
    v_exp_f32 v83, v83
    ds_write_b128 v7, v[52:55] offset:1024
    v_cndmask_b32 v57, v57, -2.0, s[86:87]
    v_exp_f32 v84, v84
    v_mfma_f32_32x32x16_bf16 v[96:111], a[72:75], v[20:23], v[96:111]
    v_exp_f32 v85, v85
    v_exp_f32 v86, v86
    ds_write_b64 v7, v[56:57] offset:2048
    v_exp_f32 v87, v87
    v_exp_f32 v88, v88
    v_mfma_f32_32x32x16_bf16 v[112:127], a[76:79], v[20:23], v[112:127]
    v_exp_f32 v89, v89
    v_exp_f32 v90, v90
    v_exp_f32 v91, v91
    v_smfmac_f32_32x32x32_bf16 v[32:47], a[8:11], v[80:87], v4
    v_exp_f32 v92, v92
    v_exp_f32 v93, v93
    v_exp_f32 v94, v94
    v_exp_f32 v95, v95
    v_exp_f32 v96, v96
    v_exp_f32 v97, v97
    v_smfmac_f32_32x32x32_bf16 v[32:47], a[12:15], v[88:95], v4
    v_exp_f32 v98, v98
    v_exp_f32 v99, v99
    v_exp_f32 v100, v100
    v_mfma_f32_32x32x4_2b_bf16 v[64:95], a[100:101], v[24:25], 0
    v_exp_f32 v101, v101
    v_exp_f32 v102, v102
    v_exp_f32 v103, v103
    v_exp_f32 v104, v104
    v_exp_f32 v105, v105
    v_exp_f32 v106, v106
    v_exp_f32 v107, v107
    v_exp_f32 v108, v108
    v_smfmac_f32_32x32x32_bf16 v[32:47], a[16:19], v[96:103], v4
    s_and_b32 s84, s90, 7
    s_mul_i32 s84, s84, 1280
    v_add_u32 v16, s84, v9
    v_add_u32 v1, s84, v10
    s_add_u32 s90, s90, 1
    v_exp_f32 v109, v109
    v_exp_f32 v110, v110
    ds_read_b128 v[26:29], v16
    ds_read_b64 v[30:31], v1
    v_exp_f32 v111, v111
    v_exp_f32 v112, v112
    v_exp_f32 v113, v113
    v_smfmac_f32_32x32x32_bf16 v[32:47], a[20:23], v[104:111], v4
    v_exp_f32 v114, v114
    v_exp_f32 v115, v115
    v_exp_f32 v116, v116
    v_mfma_f32_32x32x16_bf16 v[64:79], a[80:83], v[20:23], v[64:79]
    v_exp_f32 v117, v117
    v_exp_f32 v118, v118
    v_exp_f32 v119, v119
    v_exp_f32 v120, v120
    v_mfma_f32_32x32x16_bf16 v[80:95], a[84:87], v[20:23], v[80:95]
    v_exp_f32 v121, v121
    v_exp_f32 v122, v122
    v_exp_f32 v123, v123
    v_smfmac_f32_32x32x32_bf16 v[32:47], a[24:27], v[112:119], v4
    v_exp_f32 v124, v124
    v_exp_f32 v125, v125
    v_exp_f32 v126, v126
    v_exp_f32 v127, v127
    v_exp_f32 v64, v64
    v_exp_f32 v65, v65
    v_smfmac_f32_32x32x32_bf16 v[32:47], a[28:31], v[120:127], v4
    v_exp_f32 v66, v66
    v_exp_f32 v67, v67
    v_exp_f32 v68, v68
    v_mfma_f32_32x32x4_2b_bf16 v[96:127], a[102:103], v[24:25], 0
    v_exp_f32 v69, v69
    v_exp_f32 v70, v70
    v_exp_f32 v71, v71
    v_exp_f32 v72, v72
    v_exp_f32 v73, v73
    v_exp_f32 v74, v74
    v_exp_f32 v75, v75
    v_exp_f32 v76, v76
    v_smfmac_f32_32x32x32_bf16 v[32:47], a[32:35], v[64:71], v4
    v_exp_f32 v77, v77
    v_exp_f32 v78, v78
    v_exp_f32 v79, v79
    v_exp_f32 v80, v80
    v_exp_f32 v81, v81
    v_smfmac_f32_32x32x32_bf16 v[32:47], a[36:39], v[72:79], v4
    v_exp_f32 v82, v82
    v_exp_f32 v83, v83
    v_exp_f32 v84, v84
    v_mfma_f32_32x32x16_bf16 v[96:111], a[88:91], v[20:23], v[96:111]
    v_exp_f32 v85, v85
    v_exp_f32 v86, v86
    v_exp_f32 v87, v87
    v_exp_f32 v88, v88
    v_mfma_f32_32x32x16_bf16 v[112:127], a[92:95], v[20:23], v[112:127]
    v_exp_f32 v89, v89
    v_exp_f32 v90, v90
    v_exp_f32 v91, v91
    v_smfmac_f32_32x32x32_bf16 v[32:47], a[40:43], v[80:87], v4
    v_exp_f32 v92, v92
    v_exp_f32 v93, v93
    v_exp_f32 v94, v94
    v_exp_f32 v95, v95
    v_exp_f32 v96, v96
    v_exp_f32 v97, v97
    v_smfmac_f32_32x32x32_bf16 v[32:47], a[44:47], v[88:95], v4
    s_waitcnt lgkmcnt(0)
    v_exp_f32 v98, v98
    v_exp_f32 v99, v99
    v_exp_f32 v100, v100
    v_mfma_f32_32x32x4_2b_bf16 v[64:95], a[96:97], v[30:31], 0
    v_exp_f32 v101, v101
    v_exp_f32 v102, v102
    v_exp_f32 v103, v103
    v_exp_f32 v104, v104
    v_exp_f32 v105, v105
    v_exp_f32 v106, v106
    v_exp_f32 v107, v107
    v_exp_f32 v108, v108
    v_smfmac_f32_32x32x32_bf16 v[32:47], a[48:51], v[96:103], v4
    s_and_b32 s84, s91, 7
    s_mul_i32 s84, s84, 3072
    v_add_u32 v7, s84, v17
    s_add_u32 s91, s91, 2
    v_exp_f32 v109, v109
    v_exp_f32 v110, v110
    ds_read_b64 v[56:57], v7 offset:2048
    ds_read_b128 v[48:51], v7
    ds_read_b128 v[52:55], v7 offset:1024
    v_exp_f32 v111, v111
    v_exp_f32 v112, v112
    v_exp_f32 v113, v113
    v_smfmac_f32_32x32x32_bf16 v[32:47], a[52:55], v[104:111], v4
    v_exp_f32 v114, v114
    v_exp_f32 v115, v115
    v_exp_f32 v116, v116
    v_mfma_f32_32x32x16_bf16 v[64:79], a[64:67], v[26:29], v[64:79]
    v_exp_f32 v117, v117
    v_exp_f32 v118, v118
    v_exp_f32 v119, v119
    v_exp_f32 v120, v120
    v_mfma_f32_32x32x16_bf16 v[80:95], a[68:71], v[26:29], v[80:95]
    v_exp_f32 v121, v121
    v_exp_f32 v122, v122
    v_exp_f32 v123, v123
    v_smfmac_f32_32x32x32_bf16 v[32:47], a[56:59], v[112:119], v4
    v_exp_f32 v124, v124
    v_exp_f32 v125, v125
    v_exp_f32 v126, v126
    v_exp_f32 v127, v127
    v_exp_f32 v64, v64
    v_exp_f32 v65, v65
    v_smfmac_f32_32x32x32_bf16 v[32:47], a[60:63], v[120:127], v4
    v_exp_f32 v66, v66
    v_exp_f32 v67, v67
    v_exp_f32 v68, v68
    v_mfma_f32_32x32x4_2b_bf16 v[96:127], a[98:99], v[30:31], 0
    v_exp_f32 v69, v69
    v_exp_f32 v70, v70
    v_exp_f32 v71, v71
    v_exp_f32 v72, v72
    v_exp_f32 v73, v73
    v_exp_f32 v74, v74
    s_waitcnt lgkmcnt(0)
    v_cmp_neq_f32 vcc, -2.0, v57
    v_exp_f32 v75, v75
    s_cmp_lg_u32 vcc_hi, 0
    s_cbranch_scc1 L_RT6
L_RT6B:
    v_exp_f32 v76, v76
    v_smfmac_f32_32x32x32_bf16 v[48:63], a[0:3], v[64:71], v4
    v_exp_f32 v77, v77
    v_exp_f32 v78, v78
    ds_write_b128 v7, v[32:35]
    v_exp_f32 v79, v79
    v_exp_f32 v80, v80
    v_exp_f32 v81, v81
    v_smfmac_f32_32x32x32_bf16 v[48:63], a[4:7], v[72:79], v4
    v_exp_f32 v82, v82
    v_exp_f32 v83, v83
    ds_write_b128 v7, v[36:39] offset:1024
    v_cndmask_b32 v41, v41, -4.0, s[86:87]
    v_exp_f32 v84, v84
    v_mfma_f32_32x32x16_bf16 v[96:111], a[72:75], v[26:29], v[96:111]
    v_exp_f32 v85, v85
    v_exp_f32 v86, v86
    ds_write_b64 v7, v[40:41] offset:2048
    v_exp_f32 v87, v87
    v_exp_f32 v88, v88
    v_mfma_f32_32x32x16_bf16 v[112:127], a[76:79], v[26:29], v[112:127]
    v_exp_f32 v89, v89
    v_exp_f32 v90, v90
    v_exp_f32 v91, v91
    v_smfmac_f32_32x32x32_bf16 v[48:63], a[8:11], v[80:87], v4
    v_exp_f32 v92, v92
    v_exp_f32 v93, v93
    v_exp_f32 v94, v94
    v_exp_f32 v95, v95
    v_exp_f32 v96, v96
    v_exp_f32 v97, v97
    v_smfmac_f32_32x32x32_bf16 v[48:63], a[12:15], v[88:95], v4
    v_exp_f32 v98, v98
    v_exp_f32 v99, v99
    v_exp_f32 v100, v100
    v_mfma_f32_32x32x4_2b_bf16 v[64:95], a[100:101], v[30:31], 0
    v_exp_f32 v101, v101
    v_exp_f32 v102, v102
    v_exp_f32 v103, v103
    v_exp_f32 v104, v104
    v_exp_f32 v105, v105
    v_exp_f32 v106, v106
    v_exp_f32 v107, v107
    v_exp_f32 v108, v108
    v_smfmac_f32_32x32x32_bf16 v[48:63], a[16:19], v[96:103], v4
    v_exp_f32 v109, v109
    v_exp_f32 v110, v110
    v_exp_f32 v111, v111
    v_exp_f32 v112, v112
    v_exp_f32 v113, v113
    v_smfmac_f32_32x32x32_bf16 v[48:63], a[20:23], v[104:111], v4
    v_exp_f32 v114, v114
    v_exp_f32 v115, v115
    v_exp_f32 v116, v116
    v_mfma_f32_32x32x16_bf16 v[64:79], a[80:83], v[26:29], v[64:79]
    s_lshl_b32 s96, s76, 9
    s_lshl_b32 s97, s79, 7
    v_and_b32 v9, 7, v0
    v_lshl_add_u32 v9, v9, 4, s97
    v_add_u32 v16, s96, v5
    v_cmp_gt_u32 vcc, 32, v0
    s_nop 1
    v_cndmask_b32 v9, v9, v16, vcc
    s_mov_b32 s96, 106496
    buffer_load_dwordx4 v[44:47], v9, s[68:71], s96 offen sc1
    v_exp_f32 v117, v117
    v_exp_f32 v118, v118
    v_exp_f32 v119, v119
    v_exp_f32 v120, v120
    v_mfma_f32_32x32x16_bf16 v[80:95], a[84:87], v[26:29], v[80:95]
    v_exp_f32 v121, v121
    v_exp_f32 v122, v122
    v_exp_f32 v123, v123
    v_smfmac_f32_32x32x32_bf16 v[48:63], a[24:27], v[112:119], v4
    v_exp_f32 v124, v124
    v_exp_f32 v125, v125
    v_exp_f32 v126, v126
    v_exp_f32 v127, v127
    v_exp_f32 v64, v64
    v_exp_f32 v65, v65
    v_smfmac_f32_32x32x32_bf16 v[48:63], a[28:31], v[120:127], v4
    v_exp_f32 v66, v66
    v_exp_f32 v67, v67
    v_exp_f32 v68, v68
    v_mfma_f32_32x32x4_2b_bf16 v[96:127], a[102:103], v[30:31], 0
    v_exp_f32 v69, v69
    v_exp_f32 v70, v70
    v_exp_f32 v71, v71
    v_exp_f32 v72, v72
    v_exp_f32 v73, v73
    v_exp_f32 v74, v74
    v_exp_f32 v75, v75
    v_exp_f32 v76, v76
    v_smfmac_f32_32x32x32_bf16 v[48:63], a[32:35], v[64:71], v4
    v_exp_f32 v77, v77
    v_exp_f32 v78, v78
    v_exp_f32 v79, v79
    v_exp_f32 v80, v80
    v_exp_f32 v81, v81
    v_smfmac_f32_32x32x32_bf16 v[48:63], a[36:39], v[72:79], v4
    v_exp_f32 v82, v82
    v_exp_f32 v83, v83
    v_exp_f32 v84, v84
    v_mfma_f32_32x32x16_bf16 v[96:111], a[88:91], v[26:29], v[96:111]
    v_exp_f32 v85, v85
    v_exp_f32 v86, v86
    v_exp_f32 v87, v87
    v_exp_f32 v88, v88
    v_mfma_f32_32x32x16_bf16 v[112:127], a[92:95], v[26:29], v[112:127]
    v_exp_f32 v89, v89
    v_exp_f32 v90, v90
    v_exp_f32 v91, v91
    v_smfmac_f32_32x32x32_bf16 v[48:63], a[40:43], v[80:87], v4
    v_exp_f32 v92, v92
    v_exp_f32 v93, v93
    v_exp_f32 v94, v94
    v_exp_f32 v95, v95
    v_exp_f32 v96, v96
    v_exp_f32 v97, v97
    v_smfmac_f32_32x32x32_bf16 v[48:63], a[44:47], v[88:95], v4
    v_exp_f32 v98, v98
    v_exp_f32 v99, v99
    v_exp_f32 v100, v100
    v_exp_f32 v101, v101
    v_exp_f32 v102, v102
    v_exp_f32 v103, v103
    v_exp_f32 v104, v104
    v_exp_f32 v105, v105
    v_exp_f32 v106, v106
    v_exp_f32 v107, v107
    v_exp_f32 v108, v108
    v_smfmac_f32_32x32x32_bf16 v[48:63], a[48:51], v[96:103], v4
    s_add_u32 s84, s3, 5
    s_and_b32 s84, s84, 7
    s_mul_i32 s84, s84, 3072
    v_add_u32 v7, s84, v17
    v_exp_f32 v109, v109
    v_exp_f32 v110, v110
    ds_read_b64 v[40:41], v7 offset:2048
    ds_read_b128 v[32:35], v7
    ds_read_b128 v[36:39], v7 offset:1024
    v_exp_f32 v111, v111
    v_exp_f32 v112, v112
    v_exp_f32 v113, v113
    v_smfmac_f32_32x32x32_bf16 v[48:63], a[52:55], v[104:111], v4
    v_exp_f32 v114, v114
    v_exp_f32 v115, v115
    v_exp_f32 v116, v116
    v_exp_f32 v117, v117
    v_exp_f32 v118, v118
    v_exp_f32 v119, v119
    v_exp_f32 v120, v120
    v_exp_f32 v121, v121
    v_exp_f32 v122, v122
    v_exp_f32 v123, v123
    v_smfmac_f32_32x32x32_bf16 v[48:63], a[56:59], v[112:119], v4
    v_exp_f32 v124, v124
    v_exp_f32 v125, v125
    v_exp_f32 v126, v126
    v_exp_f32 v127, v127
    s_nop 1
    v_smfmac_f32_32x32x32_bf16 v[48:63], a[60:63], v[120:127], v4
    s_and_b32 s77, s76, 3
    s_lshr_b32 s78, s76, 2
    s_cmp_ge_u32 s76, 4
    s_cbranch_scc1 L_YEND
    v_mov_b32 v84, -1
    v_mov_b32 v85, -1
    v_mov_b32 v86, -1
    v_mov_b32 v87, -1
    s_mul_i32 s96, s79, 73728
    s_add_u32 s96, s96, 262144
    s_lshl_b32 s97, s80, 2
    s_add_u32 s97, s97, s76
    s_lshl_b32 s97, s97, 11
    s_add_u32 s99, s97, s96
    buffer_store_dwordx4 v[84:87], v5, s[68:71], s99 offen sc1
    buffer_store_dwordx4 v[84:87], v5, s[68:71], s99 offen offset:1024 sc1
    s_lshl_b32 s97, s80, 10
    s_add_u32 s96, s96, s97
    s_add_u32 s96, s96, 65536
    s_lshl_b32 s97, s81, 10
    s_add_u32 s97, s97, 2621440
    s_cmp_eq_u32 s76, 1
    s_cselect_b32 s96, s97, s96
    s_lshl_b32 s97, s81, 9
    s_add_u32 s97, s97, 2883584
    s_cmp_eq_u32 s76, 2
    s_cselect_b32 s96, s97, s96
    s_cselect_b32 s97, 32, 64
    s_cmp_eq_u32 s76, 3
    s_cselect_b32 s97, 0, s97
    v_cmp_gt_u32 vcc, s97, v0
    v_mov_b32 v18, 2146435072
    s_nop 0
    v_cndmask_b32 v12, v18, v5, vcc
    buffer_store_dwordx4 v[84:87], v12, s[68:71], s96 offen sc1
    buffer_store_dwordx4 v[84:87], v15, s[68:71], 0 offen sc1
    v_accvgpr_read_b32 v88, a104
    v_accvgpr_read_b32 v89, a105
    v_accvgpr_read_b32 v90, a106
    v_accvgpr_read_b32 v91, a107
    v_accvgpr_read_b32 v92, a108
    v_accvgpr_read_b32 v93, a109
    s_mul_i32 s96, s80, 144
    s_add_u32 s97, s76, 0
    s_lshl_b32 s97, s97, 10
    s_mov_b32 m0, s97
    s_nop 0
    buffer_load_dwordx4 v88, s[44:47], s96 offen lds
    s_add_u32 s97, s97, 9216
    s_add_u32 s96, s96, 82944
    s_mov_b32 m0, s97
    s_nop 0
    buffer_load_dwordx4 v88, s[44:47], s96 offen lds
    s_add_u32 s97, s97, 9216
    s_add_u32 s96, s96, 82944
    s_mov_b32 m0, s97
    s_nop 0
    buffer_load_dwordx4 v88, s[44:47], s96 offen lds
    s_add_u32 s97, s97, 9216
    s_add_u32 s96, s96, 82944
    s_mov_b32 m0, s97
    s_nop 0
    buffer_load_dwordx4 v88, s[44:47], s96 offen lds
    s_add_u32 s97, s97, 9216
    s_add_u32 s96, s96, 82944
    s_mov_b32 m0, s97
    s_nop 0
    buffer_load_dwordx4 v88, s[44:47], s96 offen lds
    s_add_u32 s97, s97, 9216
    s_add_u32 s96, s96, 82944
    s_mov_b32 m0, s97
    s_nop 0
    buffer_load_dwordx4 v88, s[44:47], s96 offen lds
    s_add_u32 s97, s97, 9216
    s_add_u32 s96, s96, 82944
    s_mov_b32 m0, s97
    s_nop 0
    buffer_load_dwordx4 v88, s[44:47], s96 offen lds
    s_add_u32 s97, s97, 9216
    s_add_u32 s96, s96, 82944
    s_mov_b32 m0, s97
    s_nop 0
    buffer_load_dwordx4 v88, s[44:47], s96 offen lds
    s_add_u32 s97, s97, 9216
    s_add_u32 s96, s96, 82944
    s_mul_i32 s96, s80, 144
    s_mov_b32 m0, s97
    s_nop 0
    buffer_load_dwordx4 v89, s[44:47], s96 offen lds
    s_mul_i32 s96, s80, 144
    s_add_u32 s97, s76, 4
    s_lshl_b32 s97, s97, 10
    s_mov_b32 m0, s97
    s_nop 0
    buffer_load_dwordx4 v90, s[44:47], s96 offen lds
    s_add_u32 s97, s97, 9216
    s_add_u32 s96, s96, 82944
    s_mov_b32 m0, s97
    s_nop 0
    buffer_load_dwordx4 v90, s[44:47], s96 offen lds
    s_add_u32 s97, s97, 9216
    s_add_u32 s96, s96, 82944
    s_mov_b32 m0, s97
    s_nop 0
    buffer_load_dwordx4 v90, s[44:47], s96 offen lds
    s_add_u32 s97, s97, 9216
    s_add_u32 s96, s96, 82944
    s_mov_b32 m0, s97
    s_nop 0
    buffer_load_dwordx4 v90, s[44:47], s96 offen lds
    s_add_u32 s97, s97, 9216
    s_add_u32 s96, s96, 82944
    s_mov_b32 m0, s97
    s_nop 0
    buffer_load_dwordx4 v90, s[44:47], s96 offen lds
    s_add_u32 s97, s97, 9216
    s_add_u32 s96, s96, 82944
    s_mov_b32 m0, s97
    s_nop 0
    buffer_load_dwordx4 v90, s[44:47], s96 offen lds
    s_add_u32 s97, s97, 9216
    s_add_u32 s96, s96, 82944
    s_mov_b32 m0, s97
    s_nop 0
    buffer_load_dwordx4 v90, s[44:47], s96 offen lds
    s_add_u32 s97, s97, 9216
    s_add_u32 s96, s96, 82944
    s_mov_b32 m0, s97
    s_nop 0
    buffer_load_dwordx4 v90, s[44:47], s96 offen lds
    s_add_u32 s97, s97, 9216
    s_add_u32 s96, s96, 82944
    s_mul_i32 s96, s80, 144
    s_mov_b32 m0, s97
    s_nop 0
    buffer_load_dwordx4 v91, s[44:47], s96 offen lds
    s_add_u32 s97, s76, 0
    s_mul_i32 s98, s97, 82944
    s_add_u32 s98, s98, s96
    s_mul_i32 s97, s97, 9216
    s_add_u32 m0, s97, 8192
    s_nop 0
    buffer_load_dwordx4 v92, s[44:47], s98 offen lds
    s_add_u32 s97, s76, 4
    s_mul_i32 s98, s97, 82944
    s_add_u32 s98, s98, s96
    s_mul_i32 s97, s97, 9216
    s_add_u32 m0, s97, 8192
    s_nop 0
    buffer_load_dwordx4 v92, s[44:47], s98 offen lds
    s_mov_b32 m0, 81920
    s_nop 0
    buffer_load_dwordx4 v93, s[44:47], s96 offen lds
    s_lshl_b32 s98, s79, 2
    s_add_u32 s98, s98, s76
    s_mul_i32 s98, s98, 18432
    s_add_u32 s98, s98, s96
    v_accvgpr_read_b32 v11, a114
    v_lshlrev_b32 v12, 3, v3
    buffer_load_dwordx2 v[64:65], v11, s[32:35], s98 offen offset:0
    buffer_load_dwordx2 v[74:75], v12, s[48:51], s96 offen offset:0
    buffer_load_dwordx2 v[66:67], v11, s[32:35], s98 offen offset:32
    buffer_load_dwordx2 v[76:77], v12, s[48:51], s96 offen offset:32
    buffer_load_dwordx2 v[68:69], v11, s[32:35], s98 offen offset:64
    buffer_load_dwordx2 v[78:79], v12, s[48:51], s96 offen offset:64
    buffer_load_dwordx2 v[70:71], v11, s[32:35], s98 offen offset:96
    buffer_load_dwordx2 v[80:81], v12, s[48:51], s96 offen offset:96
    buffer_load_dwordx2 v[72:73], v11, s[32:35], s98 offen offset:128
    buffer_load_dwordx2 v[82:83], v12, s[48:51], s96 offen offset:128
    s_waitcnt vmcnt(31)
    s_lshl_b32 s96, s81, 2
    s_add_u32 s96, s96, s76
    s_lshl_b32 s96, s96, 2
    s_add_u32 s96, s96, 106496
    v_mov_b32 v11, 0
    s_getreg_b32 s97, hwreg(HW_REG_XCC_ID, 0, 4)
    s_lshl_b32 s97, s97, 1
    s_xor_b32 s97, s97, s82
    v_mov_b32 v12, s97
    s_mov_b64 exec, 1
    buffer_store_dword v12, v11, s[68:71], s96 offen sc1
    s_mul_i32 s96, s79, 73728
    s_lshl_b32 s97, s80, 10
    s_add_u32 s96, s96, s97
    s_add_u32 s96, s96, 327680
    v_lshlrev_b32 v11, 7, v0
    s_mov_b64 exec, 0xff
    buffer_load_dword v43, v11, s[68:71], s96 offen sc1
    s_mov_b64 exec, -1
    v_mov_b32 v4, 1
    v_accvgpr_read_b32 v16, a113
    v_accvgpr_read_b32 v58, a110
    v_accvgpr_read_b32 v59, a111
    v_accvgpr_read_b32 v60, a112
    s_waitcnt vmcnt(12)
    v_mov_b32 v11, 159848
    s_mov_b64 exec, 1
    ds_add_u32 v11, v4
    s_mov_b64 exec, -1
    s_mov_b32 s89, 0
L_CDW:
    ds_read_b32 v12, v11
    s_waitcnt lgkmcnt(0)
    v_cmp_gt_u32 vcc, 4, v12
    s_cbranch_vccz L_CDWD
    s_add_u32 s89, s89, 1
    s_cmp_lt_u32 s89, 20000
    s_cbranch_scc1 L_CDW
L_CDWD:
    ds_read_b64_tr_b16 a[0:1], v16 offset:0
    ds_read_b64_tr_b16 a[2:3], v16 offset:144
    ds_read_b64_tr_b16 a[4:5], v16 offset:32
    ds_read_b64_tr_b16 a[6:7], v16 offset:176
    ds_read_b64_tr_b16 a[8:9], v16 offset:64
    ds_read_b64_tr_b16 a[10:11], v16 offset:208
    ds_read_b64_tr_b16 a[12:13], v16 offset:96
    ds_read_b64_tr_b16 a[14:15], v16 offset:240
    ds_read_b64_tr_b16 a[16:17], v16 offset:128
    ds_read_b64_tr_b16 a[18:19], v16 offset:272
    ds_read_b64_tr_b16 a[20:21], v16 offset:4608
    ds_read_b64_tr_b16 a[22:23], v16 offset:4752
    s_waitcnt lgkmcnt(10)
    ds_read_b64_tr_b16 a[24:25], v16 offset:4640
    ds_read_b64_tr_b16 a[26:27], v16 offset:4784
    s_waitcnt lgkmcnt(10)
    ds_read_b64_tr_b16 a[28:29], v16 offset:4672
    ds_read_b64_tr_b16 a[30:31], v16 offset:4816
    s_waitcnt lgkmcnt(10)
    ds_read_b64_tr_b16 a[32:33], v16 offset:4704
    ds_read_b64_tr_b16 a[34:35], v16 offset:4848
    s_waitcnt lgkmcnt(10)
    ds_read_b64_tr_b16 a[36:37], v16 offset:4736
    ds_read_b64_tr_b16 a[38:39], v16 offset:4880
    s_waitcnt lgkmcnt(10)
    ds_read_b64_tr_b16 a[40:41], v16 offset:9216
    ds_read_b64_tr_b16 a[42:43], v16 offset:9360
    s_waitcnt lgkmcnt(10)
    ds_read_b64_tr_b16 a[44:45], v16 offset:9248
    ds_read_b64_tr_b16 a[46:47], v16 offset:9392
    s_waitcnt lgkmcnt(10)
    ds_read_b64_tr_b16 a[48:49], v16 offset:9280
    ds_read_b64_tr_b16 a[50:51], v16 offset:9424
    s_waitcnt lgkmcnt(10)
    ds_read_b64_tr_b16 a[52:53], v16 offset:9312
    ds_read_b64_tr_b16 a[54:55], v16 offset:9456
    s_waitcnt lgkmcnt(10)
    ds_read_b64_tr_b16 a[56:57], v16 offset:9344
    ds_read_b64_tr_b16 a[58:59], v16 offset:9488
    s_waitcnt lgkmcnt(10)
    ds_read_b64_tr_b16 a[60:61], v16 offset:13824
    ds_read_b64_tr_b16 a[62:63], v16 offset:13968
    s_waitcnt lgkmcnt(10)
    ds_read_b64_tr_b16 a[64:65], v16 offset:13856
    ds_read_b64_tr_b16 a[66:67], v16 offset:14000
    s_waitcnt lgkmcnt(10)
    ds_read_b64_tr_b16 a[68:69], v16 offset:13888
    ds_read_b64_tr_b16 a[70:71], v16 offset:14032
    s_waitcnt lgkmcnt(10)
    ds_read_b64_tr_b16 a[72:73], v16 offset:13920
    ds_read_b64_tr_b16 a[74:75], v16 offset:14064
    s_waitcnt lgkmcnt(10)
    ds_read_b64_tr_b16 a[76:77], v16 offset:13952
    ds_read_b64_tr_b16 a[78:79], v16 offset:14096
    s_waitcnt lgkmcnt(10)
    ds_read_b64_tr_b16 a[80:81], v16 offset:18432
    ds_read_b64_tr_b16 a[82:83], v16 offset:18576
    s_waitcnt lgkmcnt(10)
    ds_read_b64_tr_b16 a[84:85], v16 offset:18464
    ds_read_b64_tr_b16 a[86:87], v16 offset:18608
    s_waitcnt lgkmcnt(10)
    ds_read_b64_tr_b16 a[88:89], v16 offset:18496
    ds_read_b64_tr_b16 a[90:91], v16 offset:18640
    s_waitcnt lgkmcnt(10)
    ds_read_b64_tr_b16 a[92:93], v16 offset:18528
    ds_read_b64_tr_b16 a[94:95], v16 offset:18672
    s_waitcnt lgkmcnt(10)
    ds_read_b64_tr_b16 a[96:97], v16 offset:18560
    ds_read_b64_tr_b16 a[98:99], v16 offset:18704
    s_waitcnt lgkmcnt(10)
    ds_read_b64_tr_b16 a[100:101], v16 offset:23040
    ds_read_b64_tr_b16 a[102:103], v16 offset:23184
    s_waitcnt lgkmcnt(10)
    ds_read_b64_tr_b16 a[104:105], v16 offset:23072
    ds_read_b64_tr_b16 a[106:107], v16 offset:23216
    s_waitcnt lgkmcnt(10)
    ds_read_b64_tr_b16 a[108:109], v16 offset:23104
    ds_read_b64_tr_b16 a[110:111], v16 offset:23248
    s_waitcnt lgkmcnt(10)
    ds_read_b64_tr_b16 a[112:113], v16 offset:23136
    ds_read_b64_tr_b16 a[114:115], v16 offset:23280
    s_waitcnt lgkmcnt(10)
    ds_read_b64_tr_b16 a[116:117], v16 offset:23168
    ds_read_b64_tr_b16 a[118:119], v16 offset:23312
    s_waitcnt lgkmcnt(10)
    ds_read_b64_tr_b16 a[120:121], v16 offset:27648
    ds_read_b64_tr_b16 a[122:123], v16 offset:27792
    s_waitcnt lgkmcnt(10)
    ds_read_b64_tr_b16 a[124:125], v16 offset:27680
    ds_read_b64_tr_b16 a[126:127], v16 offset:27824
    s_waitcnt lgkmcnt(10)
    ds_read_b64_tr_b16 v[84:85], v16 offset:27712
    ds_read_b64_tr_b16 v[86:87], v16 offset:27856
    s_waitcnt lgkmcnt(10)
    ds_read_b64_tr_b16 v[88:89], v16 offset:27744
    ds_read_b64_tr_b16 v[90:91], v16 offset:27888
    s_waitcnt lgkmcnt(10)
    ds_read_b64_tr_b16 v[92:93], v16 offset:27776
    ds_read_b64_tr_b16 v[94:95], v16 offset:27920
    s_waitcnt lgkmcnt(10)
    ds_read_b64_tr_b16 v[96:97], v16 offset:32256
    ds_read_b64_tr_b16 v[98:99], v16 offset:32400
    s_waitcnt lgkmcnt(10)
    ds_read_b64_tr_b16 v[100:101], v16 offset:32288
    ds_read_b64_tr_b16 v[102:103], v16 offset:32432
    s_waitcnt lgkmcnt(10)
    ds_read_b64_tr_b16 v[104:105], v16 offset:32320
    ds_read_b64_tr_b16 v[106:107], v16 offset:32464
    s_waitcnt lgkmcnt(10)
    ds_read_b64_tr_b16 v[108:109], v16 offset:32352
    ds_read_b64_tr_b16 v[110:111], v16 offset:32496
    s_waitcnt lgkmcnt(10)
    ds_read_b64_tr_b16 v[112:113], v16 offset:32384
    ds_read_b64_tr_b16 v[114:115], v16 offset:32528
    s_waitcnt lgkmcnt(10)
    ds_read_b64_tr_b16 v[116:117], v16 offset:36864
    ds_read_b64_tr_b16 v[118:119], v16 offset:37008
    s_waitcnt lgkmcnt(10)
    ds_read_b64_tr_b16 v[120:121], v16 offset:36896
    ds_read_b64_tr_b16 v[122:123], v16 offset:37040
    s_waitcnt lgkmcnt(10)
    ds_read_b64_tr_b16 v[124:125], v16 offset:36928
    ds_read_b64_tr_b16 v[126:127], v16 offset:37072
    s_waitcnt lgkmcnt(10)
    ds_read_b64_tr_b16 v[20:21], v16 offset:36960
    ds_read_b64_tr_b16 v[22:23], v16 offset:37104
    s_waitcnt lgkmcnt(10)
    ds_read_b64_tr_b16 v[24:25], v16 offset:36992
    ds_read_b64_tr_b16 v[26:27], v16 offset:37136
    s_waitcnt lgkmcnt(0)
    v_mov_b32 v11, 159852
    s_mov_b64 exec, 1
    ds_add_u32 v11, v4
    s_mov_b64 exec, -1
    s_mov_b32 s89, 0
L_CWW:
    ds_read_b32 v12, v11
    s_waitcnt lgkmcnt(0)
    v_cmp_gt_u32 vcc, 4, v12
    s_cbranch_vccz L_CWWD
    s_add_u32 s89, s89, 1
    s_cmp_lt_u32 s89, 20000
    s_cbranch_scc1 L_CWW
L_CWWD:
    s_lshl_b32 s96, s76, 1
    s_add_u32 s96, s96, 0
    s_mul_i32 s97, s96, 6912
    s_cmp_ge_u32 s96, 6
    s_cselect_b32 s98, 41472, 0
    s_add_u32 s97, s97, s98
    s_mul_i32 s96, s96, 663552
    s_mul_i32 s98, s81, 36
    s_add_u32 s96, s96, s98
    s_add_u32 s98, s96, 589824
    s_add_u32 m0, s97, 0
    s_nop 0
    buffer_load_dwordx4 v58, s[52:55], s96 offen lds
    s_add_u32 m0, s97, 1024
    s_nop 0
    buffer_load_dwordx4 v59, s[52:55], s96 offen lds
    s_add_u32 m0, s97, 2048
    s_nop 0
    buffer_load_dwordx4 v60, s[52:55], s96 offen lds
    s_add_u32 m0, s97, 3072
    s_mov_b64 exec, 0xffffff
    buffer_load_dwordx4 v58, s[52:55], s98 offen lds
    s_mov_b64 exec, -1
    s_add_u32 m0, s97, 3456
    s_nop 0
    buffer_load_dwordx4 v58, s[56:59], s96 offen lds
    s_add_u32 m0, s97, 4480
    s_nop 0
    buffer_load_dwordx4 v59, s[56:59], s96 offen lds
    s_add_u32 m0, s97, 5504
    s_nop 0
    buffer_load_dwordx4 v60, s[56:59], s96 offen lds
    s_add_u32 m0, s97, 6528
    s_mov_b64 exec, 0xffffff
    buffer_load_dwordx4 v58, s[56:59], s98 offen lds
    s_mov_b64 exec, -1
    s_lshl_b32 s96, s76, 1
    s_add_u32 s96, s96, 1
    s_mul_i32 s97, s96, 6912
    s_cmp_ge_u32 s96, 6
    s_cselect_b32 s98, 41472, 0
    s_add_u32 s97, s97, s98
    s_mul_i32 s96, s96, 663552
    s_mul_i32 s98, s81, 36
    s_add_u32 s96, s96, s98
    s_add_u32 s98, s96, 589824
    s_add_u32 m0, s97, 0
    s_nop 0
    buffer_load_dwordx4 v58, s[52:55], s96 offen lds
    s_add_u32 m0, s97, 1024
    s_nop 0
    buffer_load_dwordx4 v59, s[52:55], s96 offen lds
    s_add_u32 m0, s97, 2048
    s_nop 0
    buffer_load_dwordx4 v60, s[52:55], s96 offen lds
    s_add_u32 m0, s97, 3072
    s_mov_b64 exec, 0xffffff
    buffer_load_dwordx4 v58, s[52:55], s98 offen lds
    s_mov_b64 exec, -1
    s_add_u32 m0, s97, 3456
    s_nop 0
    buffer_load_dwordx4 v58, s[56:59], s96 offen lds
    s_add_u32 m0, s97, 4480
    s_nop 0
    buffer_load_dwordx4 v59, s[56:59], s96 offen lds
    s_add_u32 m0, s97, 5504
    s_nop 0
    buffer_load_dwordx4 v60, s[56:59], s96 offen lds
    s_add_u32 m0, s97, 6528
    s_mov_b64 exec, 0xffffff
    buffer_load_dwordx4 v58, s[56:59], s98 offen lds
    s_mov_b64 exec, -1
    s_mul_i32 s96, s81, 20736
    s_lshl_b32 s97, s76, 10
    s_add_u32 s96, s96, s97
    s_add_u32 m0, s97, 96768
    s_nop 0
    buffer_load_dwordx4 v5, s[60:63], s96 offen lds
    s_add_u32 s96, s96, 4096
    s_add_u32 m0, m0, 4096
    s_nop 0
    buffer_load_dwordx4 v5, s[60:63], s96 offen lds
    s_add_u32 s96, s96, 4096
    s_add_u32 m0, m0, 4096
    s_nop 0
    buffer_load_dwordx4 v5, s[60:63], s96 offen lds
    s_add_u32 s96, s96, 4096
    s_add_u32 m0, m0, 4096
    s_nop 0
    buffer_load_dwordx4 v5, s[60:63], s96 offen lds
    s_add_u32 s96, s96, 4096
    s_add_u32 m0, m0, 4096
    s_nop 0
    buffer_load_dwordx4 v5, s[60:63], s96 offen lds
    s_add_u32 s96, s96, 4096
    s_add_u32 m0, m0, 4096
    s_cmp_lg_u32 s76, 0
    s_cbranch_scc1 L_NOWD
    buffer_load_dwordx4 v5, s[60:63], s96 offen lds
L_NOWD:
L_BGEND:
    s_mov_b32 s89, 0
L_OW:
    s_sleep 4
    ds_read_b32 v1, v7 offset:2052
    s_waitcnt lgkmcnt(0)
    v_cmp_neq_f32 vcc, -4.0, v1
    s_mov_b32 vcc_lo, 0
    s_cbranch_vccz L_OWD
    s_add_u32 s89, s89, 1
    s_cmp_lt_u32 s89, 20000
    s_cbranch_scc1 L_OW
L_OWD:
    s_mov_b32 s96, 106496
    buffer_load_dwordx4 v[44:47], v9, s[68:71], s96 offen sc1
    ds_read_b64 v[40:41], v7 offset:2048
    ds_read_b128 v[32:35], v7
    ds_read_b128 v[36:39], v7 offset:1024
    s_waitcnt lgkmcnt(0)
    s_branch L_PUB
L_YEND:
    s_waitcnt lgkmcnt(0)
    v_cmp_neq_f32 vcc, -4.0, v41
    s_nop 0
    s_cmp_lg_u32 vcc_hi, 0
    s_cbranch_scc1 L_RT7
L_RT7B:
L_PUB:
    s_getreg_b32 s97, hwreg(HW_REG_XCC_ID, 0, 4)
    s_lshl_b32 s97, s97, 1
    s_xor_b32 s97, s97, s82
    s_waitcnt vmcnt(0)
    v_cmp_ne_u32 vcc, s97, v44
    s_nop 0
    s_cmp_eq_u32 vcc_hi, 0
    s_cselect_b32 s88, 1, 0
    s_add_u32 s84, s3, 7
    s_and_b32 s84, s84, 7
    s_and_b32 s85, s84, 1
    s_lshl_b32 s85, s85, 9
    s_lshr_b32 s84, s84, 1
    s_mul_i32 s30, s79, 73728
    s_add_u32 s30, s30, 262144
    s_add_u32 s30, s30, s85
    s_lshl_b32 s85, s80, 2
    s_add_u32 s85, s85, s84
    s_lshl_b32 s85, s85, 11
    s_add_u32 s85, s85, s30
    s_lshl_b32 s31, s80, 10
    s_add_u32 s30, s30, s31
    s_lshl_b32 s84, s84, 2
    s_add_u32 s30, s30, s84
    s_add_u32 s30, s30, 65536
    v_and_b32 v8, 31, v0
    v_lshlrev_b32 v8, 4, v8
    v_lshrrev_b32 v6, 5, v0
    v_lshl_add_u32 v6, v6, 10, v8
    v_cmp_gt_u32 vcc, 32, v0
    v_mov_b32 v7, 2146435072
    s_nop 0
    v_cndmask_b32 v8, v7, v8, vcc
    v_pk_add_f32 v[32:33], v[32:33], v[48:49]
    v_pk_add_f32 v[34:35], v[34:35], v[50:51]
    v_pk_add_f32 v[36:37], v[36:37], v[52:53]
    v_pk_add_f32 v[38:39], v[38:39], v[54:55]
    v_pk_add_f32 v[40:41], v[40:41], v[56:57]
    v_mov_b32 v42, v40
    v_mov_b32 v43, v40
    s_nop 1
    v_permlane32_swap_b32 v42, v43
    v_rcp_f32 v43, v43
    s_nop 0
    v_mov_b32 v42, v43
    v_pk_mul_f32 v[32:33], v[32:33], v[42:43]
    v_pk_mul_f32 v[34:35], v[34:35], v[42:43]
    v_pk_mul_f32 v[36:37], v[36:37], v[42:43]
    v_pk_mul_f32 v[38:39], v[38:39], v[42:43]
    v_pk_mul_f32 v[40:41], v[40:41], v[42:43]
    v_cvt_pk_bf16_f32 v48, v32, v33
    v_cvt_pk_bf16_f32 v49, v34, v35
    v_cvt_pk_bf16_f32 v50, v36, v37
    v_cvt_pk_bf16_f32 v51, v38, v39
    v_cvt_pk_bf16_f32 v52, v40, v41
    s_cmp_eq_u32 s88, 0
    s_cbranch_scc1 L_PUBW
    buffer_store_dwordx4 v[48:51], v6, s[68:71], s85 offen
    buffer_store_dword v52, v8, s[68:71], s30 offen
    s_branch L_PUBX
L_PUBW:
    buffer_store_dwordx4 v[48:51], v6, s[68:71], s85 offen sc1
    buffer_store_dword v52, v8, s[68:71], s30 offen sc1
L_PUBX:
    v_mov_b32 v11, 159848
    ds_read_b32 v12, v11
    s_mul_i32 s84, s78, 36
    v_add_u32 v8, s84, v3
    v_lshlrev_b32 v8, 10, v8
    v_lshl_add_u32 v8, v2, 4, v8
    s_mul_i32 s84, s79, 73728
    s_lshl_b32 s85, s77, 8
    s_add_u32 s84, s84, s85
    s_add_u32 s94, s84, 262144
    s_add_u32 s95, s94, 4096
    s_add_u32 s96, s94, 8192
    s_add_u32 s97, s94, 12288
    s_add_u32 s98, s94, 16384
    s_add_u32 s99, s94, 20480
    s_add_u32 s100, s94, 24576
    s_add_u32 s101, s94, 28672
    s_add_u32 s31, s94, 32768
    s_waitcnt vmcnt(2)
    v_xor_b32 v44, s82, v44
    v_xor_b32 v45, s82, v45
    v_xor_b32 v46, s82, v46
    v_xor_b32 v47, s82, v47
    v_or3_b32 v44, v44, v45, v46
    v_or_b32 v44, v44, v47
    v_cmp_lt_u32 vcc, 31, v44
    s_cbranch_vccz L_CLOK
    s_mov_b32 s89, 0
L_CLS:
    s_mov_b32 s30, 106496
    buffer_load_dwordx4 v[44:47], v9, s[68:71], s30 offen sc1
    s_waitcnt vmcnt(0)
    v_xor_b32 v44, s82, v44
    v_xor_b32 v45, s82, v45
    v_xor_b32 v46, s82, v46
    v_xor_b32 v47, s82, v47
    v_or3_b32 v44, v44, v45, v46
    v_or_b32 v44, v44, v47
    v_cmp_lt_u32 vcc, 31, v44
    s_cbranch_vccz L_CLOK
    s_add_u32 s89, s89, 1
    s_cmp_lt_u32 s89, 20000
    s_cbranch_scc1 L_CLS
L_CLOK:
    s_cmp_eq_u32 s78, 0
    s_cbranch_scc1 L_NOPRE
    v_accvgpr_read_b32 v16, a113
    s_waitcnt lgkmcnt(0)
    v_cmp_gt_u32 vcc, 4, v12
    s_cbranch_vccz L_CDYD
    s_mov_b32 s89, 0
L_CDY:
    ds_read_b32 v12, v11
    s_waitcnt lgkmcnt(0)
    v_cmp_gt_u32 vcc, 4, v12
    s_cbranch_vccz L_CDYD
    s_add_u32 s89, s89, 1
    s_cmp_lt_u32 s89, 20000
    s_cbranch_scc1 L_CDY
L_CDYD:
    ds_read_b64_tr_b16 a[0:1], v16 offset:0
    ds_read_b64_tr_b16 a[2:3], v16 offset:144
    v_mov_b32 v64, 0
    v_mov_b32 v65, 0
    ds_read_b64_tr_b16 a[4:5], v16 offset:32
    ds_read_b64_tr_b16 a[6:7], v16 offset:176
    v_mov_b32 v66, 0
    v_mov_b32 v67, 0
    ds_read_b64_tr_b16 a[8:9], v16 offset:64
    ds_read_b64_tr_b16 a[10:11], v16 offset:208
    v_mov_b32 v68, 0
    v_mov_b32 v69, 0
    ds_read_b64_tr_b16 a[12:13], v16 offset:96
    ds_read_b64_tr_b16 a[14:15], v16 offset:240
    v_mov_b32 v70, 0
    v_mov_b32 v71, 0
    ds_read_b64_tr_b16 a[16:17], v16 offset:128
    ds_read_b64_tr_b16 a[18:19], v16 offset:272
    v_mov_b32 v72, 0
    v_mov_b32 v73, 0
    ds_read_b64_tr_b16 a[20:21], v16 offset:4608
    ds_read_b64_tr_b16 a[22:23], v16 offset:4752
    v_mov_b32 v74, 0
    v_mov_b32 v75, 0
    s_waitcnt lgkmcnt(10)
    ds_read_b64_tr_b16 a[24:25], v16 offset:4640
    ds_read_b64_tr_b16 a[26:27], v16 offset:4784
    v_mov_b32 v76, 0
    v_mov_b32 v77, 0
    s_waitcnt lgkmcnt(10)
    ds_read_b64_tr_b16 a[28:29], v16 offset:4672
    ds_read_b64_tr_b16 a[30:31], v16 offset:4816
    v_mov_b32 v78, 0
    v_mov_b32 v79, 0
    s_waitcnt lgkmcnt(10)
    ds_read_b64_tr_b16 a[32:33], v16 offset:4704
    ds_read_b64_tr_b16 a[34:35], v16 offset:4848
    v_mov_b32 v80, 0
    v_mov_b32 v81, 0
    s_waitcnt lgkmcnt(10)
    ds_read_b64_tr_b16 a[36:37], v16 offset:4736
    ds_read_b64_tr_b16 a[38:39], v16 offset:4880
    v_mov_b32 v82, 0
    v_mov_b32 v83, 0
    s_waitcnt lgkmcnt(10)
    ds_read_b64_tr_b16 a[40:41], v16 offset:9216
    ds_read_b64_tr_b16 a[42:43], v16 offset:9360
    s_waitcnt lgkmcnt(10)
    ds_read_b64_tr_b16 a[44:45], v16 offset:9248
    ds_read_b64_tr_b16 a[46:47], v16 offset:9392
    s_waitcnt lgkmcnt(10)
    ds_read_b64_tr_b16 a[48:49], v16 offset:9280
    ds_read_b64_tr_b16 a[50:51], v16 offset:9424
    s_waitcnt lgkmcnt(10)
    ds_read_b64_tr_b16 a[52:53], v16 offset:9312
    ds_read_b64_tr_b16 a[54:55], v16 offset:9456
    s_waitcnt lgkmcnt(10)
    ds_read_b64_tr_b16 a[56:57], v16 offset:9344
    ds_read_b64_tr_b16 a[58:59], v16 offset:9488
    s_waitcnt lgkmcnt(10)
    ds_read_b64_tr_b16 a[60:61], v16 offset:13824
    ds_read_b64_tr_b16 a[62:63], v16 offset:13968
    s_waitcnt lgkmcnt(10)
    ds_read_b64_tr_b16 a[64:65], v16 offset:13856
    ds_read_b64_tr_b16 a[66:67], v16 offset:14000
    s_waitcnt lgkmcnt(10)
    ds_read_b64_tr_b16 a[68:69], v16 offset:13888
    ds_read_b64_tr_b16 a[70:71], v16 offset:14032
    s_waitcnt vmcnt(0)
    s_barrier
    buffer_load_dwordx4 v[28:31], v8, s[68:71], s94 offen sc1
    s_waitcnt lgkmcnt(10)
    ds_read_b64_tr_b16 a[72:73], v16 offset:13920
    ds_read_b64_tr_b16 a[74:75], v16 offset:14064
    s_waitcnt lgkmcnt(10)
    ds_read_b64_tr_b16 a[76:77], v16 offset:13952
    ds_read_b64_tr_b16 a[78:79], v16 offset:14096
    s_waitcnt lgkmcnt(10)
    ds_read_b64_tr_b16 a[80:81], v16 offset:18432
    ds_read_b64_tr_b16 a[82:83], v16 offset:18576
    s_waitcnt lgkmcnt(10)
    ds_read_b64_tr_b16 a[84:85], v16 offset:18464
    ds_read_b64_tr_b16 a[86:87], v16 offset:18608
    s_waitcnt lgkmcnt(10)
    ds_read_b64_tr_b16 a[88:89], v16 offset:18496
    ds_read_b64_tr_b16 a[90:91], v16 offset:18640
    s_waitcnt lgkmcnt(10)
    ds_read_b64_tr_b16 a[92:93], v16 offset:18528
    ds_read_b64_tr_b16 a[94:95], v16 offset:18672
    s_waitcnt lgkmcnt(10)
    ds_read_b64_tr_b16 a[96:97], v16 offset:18560
    ds_read_b64_tr_b16 a[98:99], v16 offset:18704
    buffer_load_dwordx4 v[32:35], v8, s[68:71], s95 offen sc1
    s_waitcnt lgkmcnt(10)
    ds_read_b64_tr_b16 a[100:101], v16 offset:23040
    ds_read_b64_tr_b16 a[102:103], v16 offset:23184
    s_waitcnt lgkmcnt(10)
    ds_read_b64_tr_b16 a[104:105], v16 offset:23072
    ds_read_b64_tr_b16 a[106:107], v16 offset:23216
    s_waitcnt lgkmcnt(10)
    ds_read_b64_tr_b16 a[108:109], v16 offset:23104
    ds_read_b64_tr_b16 a[110:111], v16 offset:23248
    s_waitcnt lgkmcnt(10)
    ds_read_b64_tr_b16 a[112:113], v16 offset:23136
    ds_read_b64_tr_b16 a[114:115], v16 offset:23280
    s_waitcnt lgkmcnt(10)
    ds_read_b64_tr_b16 a[116:117], v16 offset:23168
    ds_read_b64_tr_b16 a[118:119], v16 offset:23312
    s_waitcnt lgkmcnt(10)
    ds_read_b64_tr_b16 a[120:121], v16 offset:27648
    ds_read_b64_tr_b16 a[122:123], v16 offset:27792
    s_waitcnt lgkmcnt(10)
    ds_read_b64_tr_b16 a[124:125], v16 offset:27680
    ds_read_b64_tr_b16 a[126:127], v16 offset:27824
    buffer_load_dwordx4 v[36:39], v8, s[68:71], s96 offen sc1
    s_waitcnt lgkmcnt(10)
    ds_read_b64_tr_b16 v[84:85], v16 offset:27712
    ds_read_b64_tr_b16 v[86:87], v16 offset:27856
    s_waitcnt lgkmcnt(10)
    ds_read_b64_tr_b16 v[88:89], v16 offset:27744
    ds_read_b64_tr_b16 v[90:91], v16 offset:27888
    s_waitcnt lgkmcnt(10)
    ds_read_b64_tr_b16 v[92:93], v16 offset:27776
    ds_read_b64_tr_b16 v[94:95], v16 offset:27920
    s_waitcnt lgkmcnt(10)
    ds_read_b64_tr_b16 v[96:97], v16 offset:32256
    ds_read_b64_tr_b16 v[98:99], v16 offset:32400
    s_waitcnt lgkmcnt(10)
    ds_read_b64_tr_b16 v[100:101], v16 offset:32288
    ds_read_b64_tr_b16 v[102:103], v16 offset:32432
    s_waitcnt lgkmcnt(10)
    ds_read_b64_tr_b16 v[104:105], v16 offset:32320
    ds_read_b64_tr_b16 v[106:107], v16 offset:32464
    s_waitcnt lgkmcnt(10)
    ds_read_b64_tr_b16 v[108:109], v16 offset:32352
    ds_read_b64_tr_b16 v[110:111], v16 offset:32496
    buffer_load_dwordx4 v[40:43], v8, s[68:71], s97 offen sc1
    s_waitcnt lgkmcnt(10)
    ds_read_b64_tr_b16 v[112:113], v16 offset:32384
    ds_read_b64_tr_b16 v[114:115], v16 offset:32528
    s_waitcnt lgkmcnt(10)
    ds_read_b64_tr_b16 v[116:117], v16 offset:36864
    ds_read_b64_tr_b16 v[118:119], v16 offset:37008
    s_waitcnt lgkmcnt(10)
    ds_read_b64_tr_b16 v[120:121], v16 offset:36896
    ds_read_b64_tr_b16 v[122:123], v16 offset:37040
    s_waitcnt lgkmcnt(10)
    ds_read_b64_tr_b16 v[124:125], v16 offset:36928
    ds_read_b64_tr_b16 v[126:127], v16 offset:37072
    s_waitcnt lgkmcnt(10)
    ds_read_b64_tr_b16 v[20:21], v16 offset:36960
    ds_read_b64_tr_b16 v[22:23], v16 offset:37104
    s_waitcnt lgkmcnt(10)
    ds_read_b64_tr_b16 v[24:25], v16 offset:36992
    ds_read_b64_tr_b16 v[26:27], v16 offset:37136
    s_waitcnt lgkmcnt(0)
    s_branch L_LCHK
L_NOPRE:
    v_mul_u32_u24 v13, 40, v3
    v_add_u32 v13, 162048, v13
    v_cmp_gt_u32 vcc, 32, v0
    v_dot2_f32_bf16 v19, v74, s83, 0
    v_dot2_f32_bf16 v19, v75, s83, v19
    v_dot2_f32_bf16 v19, v76, s83, v19
    v_dot2_f32_bf16 v19, v77, s83, v19
    v_dot2_f32_bf16 v19, v78, s83, v19
    v_dot2_f32_bf16 v19, v79, s83, v19
    v_dot2_f32_bf16 v19, v80, s83, v19
    v_dot2_f32_bf16 v19, v81, s83, v19
    v_cndmask_b32 v82, 0, v82, vcc
    v_dot2_f32_bf16 v19, v82, s83, v19
    v_cndmask_b32 v83, 0, v83, vcc
    v_dot2_f32_bf16 v19, v83, s83, v19
    ds_write_b64 v13, v[74:75] offset:0
    ds_write_b64 v13, v[76:77] offset:8
    ds_write_b64 v13, v[78:79] offset:16
    ds_write_b64 v13, v[80:81] offset:24
    ds_write_b64 v13, v[82:83] offset:32
    s_waitcnt lgkmcnt(0)
    v_and_b32 v83, 0xffff0000, v73
    v_lshlrev_b32 v82, 16, v73
    v_and_b32 v81, 0xffff0000, v72
    v_lshlrev_b32 v80, 16, v72
    v_and_b32 v79, 0xffff0000, v71
    v_lshlrev_b32 v78, 16, v71
    v_and_b32 v77, 0xffff0000, v70
    v_lshlrev_b32 v76, 16, v70
    v_and_b32 v75, 0xffff0000, v69
    v_lshlrev_b32 v74, 16, v69
    v_and_b32 v73, 0xffff0000, v68
    v_lshlrev_b32 v72, 16, v68
    v_and_b32 v71, 0xffff0000, v67
    v_lshlrev_b32 v70, 16, v67
    v_and_b32 v69, 0xffff0000, v66
    v_lshlrev_b32 v68, 16, v66
    v_and_b32 v67, 0xffff0000, v65
    v_lshlrev_b32 v66, 16, v65
    v_and_b32 v65, 0xffff0000, v64
    v_lshlrev_b32 v64, 16, v64
    s_waitcnt vmcnt(0) lgkmcnt(0)
    s_barrier
    buffer_load_dwordx4 v[28:31], v8, s[68:71], s94 offen sc1
    buffer_load_dwordx4 v[32:35], v8, s[68:71], s95 offen sc1
    buffer_load_dwordx4 v[36:39], v8, s[68:71], s96 offen sc1
    buffer_load_dwordx4 v[40:43], v8, s[68:71], s97 offen sc1
L_LCHK:
    buffer_load_dwordx4 v[44:47], v8, s[68:71], s98 offen sc1
    s_waitcnt vmcnt(4)
    v_max3_u32 v7, v28, v29, v30
    v_max_u32 v7, v7, v31
    v_cmp_eq_u32 vcc, -1, v7
    s_cbranch_vccnz L_OR0
L_OR0B:
    v_mfma_f32_16x16x32_bf16 v[64:67], a[0:3], v[28:31], v[64:67]
    v_mfma_f32_16x16x32_bf16 v[68:71], a[4:7], v[28:31], v[68:71]
    v_mfma_f32_16x16x32_bf16 v[72:75], a[8:11], v[28:31], v[72:75]
    v_mfma_f32_16x16x32_bf16 v[76:79], a[12:15], v[28:31], v[76:79]
    v_mfma_f32_16x16x32_bf16 v[80:83], a[16:19], v[28:31], v[80:83]
    buffer_load_dwordx4 v[48:51], v8, s[68:71], s99 offen sc1
    s_waitcnt vmcnt(4)
    v_max3_u32 v7, v32, v33, v34
    v_max_u32 v7, v7, v35
    v_cmp_eq_u32 vcc, -1, v7
    s_cbranch_vccnz L_OR1
L_OR1B:
    v_mfma_f32_16x16x32_bf16 v[64:67], a[20:23], v[32:35], v[64:67]
    v_mfma_f32_16x16x32_bf16 v[68:71], a[24:27], v[32:35], v[68:71]
    v_mfma_f32_16x16x32_bf16 v[72:75], a[28:31], v[32:35], v[72:75]
    v_mfma_f32_16x16x32_bf16 v[76:79], a[32:35], v[32:35], v[76:79]
    v_mfma_f32_16x16x32_bf16 v[80:83], a[36:39], v[32:35], v[80:83]
    buffer_load_dwordx4 v[52:55], v8, s[68:71], s100 offen sc1
    s_waitcnt vmcnt(4)
    v_max3_u32 v7, v36, v37, v38
    v_max_u32 v7, v7, v39
    v_cmp_eq_u32 vcc, -1, v7
    s_cbranch_vccnz L_OR2
L_OR2B:
    v_mfma_f32_16x16x32_bf16 v[64:67], a[40:43], v[36:39], v[64:67]
    v_mfma_f32_16x16x32_bf16 v[68:71], a[44:47], v[36:39], v[68:71]
    v_mfma_f32_16x16x32_bf16 v[72:75], a[48:51], v[36:39], v[72:75]
    v_mfma_f32_16x16x32_bf16 v[76:79], a[52:55], v[36:39], v[76:79]
    v_mfma_f32_16x16x32_bf16 v[80:83], a[56:59], v[36:39], v[80:83]
    buffer_load_dwordx4 v[56:59], v8, s[68:71], s101 offen sc1
    s_waitcnt vmcnt(4)
    v_max3_u32 v7, v40, v41, v42
    v_max_u32 v7, v7, v43
    v_cmp_eq_u32 vcc, -1, v7
    s_cbranch_vccnz L_OR3
L_OR3B:
    v_mfma_f32_16x16x32_bf16 v[64:67], a[60:63], v[40:43], v[64:67]
    v_mfma_f32_16x16x32_bf16 v[68:71], a[64:67], v[40:43], v[68:71]
    v_mfma_f32_16x16x32_bf16 v[72:75], a[68:71], v[40:43], v[72:75]
    v_mfma_f32_16x16x32_bf16 v[76:79], a[72:75], v[40:43], v[76:79]
    v_mfma_f32_16x16x32_bf16 v[80:83], a[76:79], v[40:43], v[80:83]
    buffer_load_dwordx4 v[60:63], v8, s[68:71], s31 offen sc1
    s_waitcnt vmcnt(4)
    v_max3_u32 v7, v44, v45, v46
    v_max_u32 v7, v7, v47
    v_cmp_eq_u32 vcc, -1, v7
    s_cbranch_vccnz L_OR4
L_OR4B:
    v_mfma_f32_16x16x32_bf16 v[64:67], a[80:83], v[44:47], v[64:67]
    v_mfma_f32_16x16x32_bf16 v[68:71], a[84:87], v[44:47], v[68:71]
    v_mfma_f32_16x16x32_bf16 v[72:75], a[88:91], v[44:47], v[72:75]
    v_mfma_f32_16x16x32_bf16 v[76:79], a[92:95], v[44:47], v[76:79]
    v_mfma_f32_16x16x32_bf16 v[80:83], a[96:99], v[44:47], v[80:83]
    s_waitcnt vmcnt(3)
    v_max3_u32 v7, v48, v49, v50
    v_max_u32 v7, v7, v51
    v_cmp_eq_u32 vcc, -1, v7
    s_cbranch_vccnz L_OR5
L_OR5B:
    v_mfma_f32_16x16x32_bf16 v[64:67], a[100:103], v[48:51], v[64:67]
    v_mfma_f32_16x16x32_bf16 v[68:71], a[104:107], v[48:51], v[68:71]
    v_mfma_f32_16x16x32_bf16 v[72:75], a[108:111], v[48:51], v[72:75]
    v_mfma_f32_16x16x32_bf16 v[76:79], a[112:115], v[48:51], v[76:79]
    v_mfma_f32_16x16x32_bf16 v[80:83], a[116:119], v[48:51], v[80:83]
    s_waitcnt vmcnt(2)
    v_max3_u32 v7, v52, v53, v54
    v_max_u32 v7, v7, v55
    v_cmp_eq_u32 vcc, -1, v7
    s_cbranch_vccnz L_OR6
L_OR6B:
    v_mfma_f32_16x16x32_bf16 v[64:67], a[120:123], v[52:55], v[64:67]
    v_mfma_f32_16x16x32_bf16 v[68:71], a[124:127], v[52:55], v[68:71]
    v_mfma_f32_16x16x32_bf16 v[72:75], v[84:87], v[52:55], v[72:75]
    v_mfma_f32_16x16x32_bf16 v[76:79], v[88:91], v[52:55], v[76:79]
    v_mfma_f32_16x16x32_bf16 v[80:83], v[92:95], v[52:55], v[80:83]
    s_waitcnt vmcnt(1)
    v_max3_u32 v7, v56, v57, v58
    v_max_u32 v7, v7, v59
    v_cmp_eq_u32 vcc, -1, v7
    s_cbranch_vccnz L_OR7
L_OR7B:
    v_mfma_f32_16x16x32_bf16 v[64:67], v[96:99], v[56:59], v[64:67]
    v_mfma_f32_16x16x32_bf16 v[68:71], v[100:103], v[56:59], v[68:71]
    v_mfma_f32_16x16x32_bf16 v[72:75], v[104:107], v[56:59], v[72:75]
    v_mfma_f32_16x16x32_bf16 v[76:79], v[108:111], v[56:59], v[76:79]
    v_mfma_f32_16x16x32_bf16 v[80:83], v[112:115], v[56:59], v[80:83]
    s_waitcnt vmcnt(0)
    v_max3_u32 v7, v60, v61, v62
    v_max_u32 v7, v7, v63
    v_cmp_eq_u32 vcc, -1, v7
    s_cbranch_vccnz L_OR8
L_OR8B:
    v_mfma_f32_16x16x32_bf16 v[64:67], v[116:119], v[60:63], v[64:67]
    v_mfma_f32_16x16x32_bf16 v[68:71], v[120:123], v[60:63], v[68:71]
    v_mfma_f32_16x16x32_bf16 v[72:75], v[124:127], v[60:63], v[72:75]
    v_mfma_f32_16x16x32_bf16 v[76:79], v[20:23], v[60:63], v[76:79]
    v_mfma_f32_16x16x32_bf16 v[80:83], v[24:27], v[60:63], v[80:83]
    s_mul_i32 s84, s77, 5120
    s_add_u32 s84, s84, 138240
    v_lshl_add_u32 v6, v0, 4, s84
    s_cmp_eq_u32 s78, 0
    s_cbranch_scc1 L_P3A
    ds_write_b128 v6, v[64:67] offset:0
    ds_write_b128 v6, v[68:71] offset:1024
    ds_write_b128 v6, v[72:75] offset:2048
    ds_write_b128 v6, v[76:79] offset:3072
    ds_write_b128 v6, v[80:83] offset:4096
    s_waitcnt lgkmcnt(0)
    s_barrier
    s_mul_i32 s84, s76, 6912
    s_cmp_ge_u32 s76, 6
    s_cselect_b32 s94, 41472, 0
    s_add_u32 s84, s84, s94
    v_mul_u32_u24 v5, 864, v3
    v_cmp_gt_u32 vcc, 8, v2
    s_nop 1
    v_cndmask_b32 v1, 11, v2, vcc
    v_lshl_add_u32 v5, v1, 2, v5
    v_add_u32 v5, s84, v5
    s_mov_b32 s94, 0x05040100
    s_mov_b32 s95, 0x07060302
    ds_read_b32 v92, v5 offset:0
    ds_read_b32 v93, v5 offset:48
    ds_read_b32 v94, v5 offset:96
    ds_read_b32 v95, v5 offset:144
    ds_read_b32 v96, v5 offset:192
    ds_read_b32 v97, v5 offset:240
    ds_read_b32 v98, v5 offset:288
    ds_read_b32 v99, v5 offset:336
    ds_read_b32 v100, v5 offset:384
    ds_read_b32 v101, v5 offset:432
    ds_read_b32 v102, v5 offset:480
    ds_read_b32 v103, v5 offset:528
    s_waitcnt lgkmcnt(4)
    ds_read_b32 v104, v5 offset:576
    ds_read_b32 v105, v5 offset:624
    ds_read_b32 v106, v5 offset:672
    ds_read_b32 v107, v5 offset:720
    ds_read_b32 v108, v5 offset:768
    ds_read_b32 v109, v5 offset:816
    s_waitcnt lgkmcnt(0)
    v_perm_b32 v1, v93, v92, s94
    v_perm_b32 v93, v93, v92, s95
    v_mov_b32 v92, v1
    v_perm_b32 v1, v95, v94, s94
    v_perm_b32 v95, v95, v94, s95
    v_mov_b32 v94, v1
    v_perm_b32 v1, v97, v96, s94
    v_perm_b32 v97, v97, v96, s95
    v_mov_b32 v96, v1
    v_perm_b32 v1, v99, v98, s94
    v_perm_b32 v99, v99, v98, s95
    v_mov_b32 v98, v1
    v_perm_b32 v1, v101, v100, s94
    v_perm_b32 v101, v101, v100, s95
    v_mov_b32 v100, v1
    v_perm_b32 v1, v103, v102, s94
    v_perm_b32 v103, v103, v102, s95
    v_mov_b32 v102, v1
    v_perm_b32 v1, v105, v104, s94
    v_perm_b32 v105, v105, v104, s95
    v_mov_b32 v104, v1
    v_perm_b32 v1, v107, v106, s94
    v_perm_b32 v107, v107, v106, s95
    v_mov_b32 v106, v1
    v_perm_b32 v1, v109, v108, s94
    v_perm_b32 v109, v109, v108, s95
    v_mov_b32 v108, v1
    ds_read_b32 v110, v5 offset:3456
    ds_read_b32 v111, v5 offset:3504
    ds_read_b32 v112, v5 offset:3552
    ds_read_b32 v113, v5 offset:3600
    ds_read_b32 v114, v5 offset:3648
    ds_read_b32 v115, v5 offset:3696
    ds_read_b32 v116, v5 offset:3744
    ds_read_b32 v117, v5 offset:3792
    ds_read_b32 v118, v5 offset:3840
    ds_read_b32 v119, v5 offset:3888
    ds_read_b32 v120, v5 offset:3936
    ds_read_b32 v121, v5 offset:3984
    s_waitcnt lgkmcnt(4)
    ds_read_b32 v122, v5 offset:4032
    ds_read_b32 v123, v5 offset:4080
    ds_read_b32 v124, v5 offset:4128
    ds_read_b32 v125, v5 offset:4176
    ds_read_b32 v126, v5 offset:4224
    ds_read_b32 v127, v5 offset:4272
    s_waitcnt lgkmcnt(0)
    v_perm_b32 v1, v111, v110, s94
    v_perm_b32 v111, v111, v110, s95
    v_mov_b32 v110, v1
    v_perm_b32 v1, v113, v112, s94
    v_perm_b32 v113, v113, v112, s95
    v_mov_b32 v112, v1
    v_perm_b32 v1, v115, v114, s94
    v_perm_b32 v115, v115, v114, s95
    v_mov_b32 v114, v1
    v_perm_b32 v1, v117, v116, s94
    v_perm_b32 v117, v117, v116, s95
    v_mov_b32 v116, v1
    v_perm_b32 v1, v119, v118, s94
    v_perm_b32 v119, v119, v118, s95
    v_mov_b32 v118, v1
    v_perm_b32 v1, v121, v120, s94
    v_perm_b32 v121, v121, v120, s95
    v_mov_b32 v120, v1
    v_perm_b32 v1, v123, v122, s94
    v_perm_b32 v123, v123, v122, s95
    v_mov_b32 v122, v1
    v_perm_b32 v1, v125, v124, s94
    v_perm_b32 v125, v125, v124, s95
    v_mov_b32 v124, v1
    v_perm_b32 v1, v127, v126, s94
    v_perm_b32 v127, v127, v126, s95
    v_mov_b32 v126, v1
    s_mul_i32 s84, s77, 288
    s_add_u32 s84, s84, 96768
    v_min_u32 v6, 35, v0
    v_lshl_add_u32 v6, v6, 3, s84
    ds_read_b64 v[52:53], v6 offset:0
    ds_read_b64 v[54:55], v6 offset:1152
    ds_read_b64 v[56:57], v6 offset:2304
    ds_read_b64 v[58:59], v6 offset:3456
    ds_read_b64 v[60:61], v6 offset:4608
    ds_read_b64 v[62:63], v6 offset:5760
    ds_read_b64 v[64:65], v6 offset:6912
    ds_read_b64 v[66:67], v6 offset:8064
    ds_read_b64 v[68:69], v6 offset:9216
    ds_read_b64 v[70:71], v6 offset:10368
    ds_read_b64 v[72:73], v6 offset:11520
    ds_read_b64 v[74:75], v6 offset:12672
    s_waitcnt lgkmcnt(4)
    ds_read_b64 v[76:77], v6 offset:13824
    ds_read_b64 v[78:79], v6 offset:14976
    ds_read_b64 v[80:81], v6 offset:16128
    ds_read_b64 v[82:83], v6 offset:17280
    ds_read_b64 v[84:85], v6 offset:18432
    ds_read_b64 v[86:87], v6 offset:19584
    s_waitcnt lgkmcnt(0)
    v_perm_b32 v1, v54, v52, s94
    v_perm_b32 v54, v54, v52, s95
    v_mov_b32 v52, v1
    v_perm_b32 v1, v55, v53, s94
    v_perm_b32 v55, v55, v53, s95
    v_mov_b32 v53, v1
    v_perm_b32 v1, v58, v56, s94
    v_perm_b32 v58, v58, v56, s95
    v_mov_b32 v56, v1
    v_perm_b32 v1, v59, v57, s94
    v_perm_b32 v59, v59, v57, s95
    v_mov_b32 v57, v1
    v_perm_b32 v1, v62, v60, s94
    v_perm_b32 v62, v62, v60, s95
    v_mov_b32 v60, v1
    v_perm_b32 v1, v63, v61, s94
    v_perm_b32 v63, v63, v61, s95
    v_mov_b32 v61, v1
    v_perm_b32 v1, v66, v64, s94
    v_perm_b32 v66, v66, v64, s95
    v_mov_b32 v64, v1
    v_perm_b32 v1, v67, v65, s94
    v_perm_b32 v67, v67, v65, s95
    v_mov_b32 v65, v1
    v_perm_b32 v1, v70, v68, s94
    v_perm_b32 v70, v70, v68, s95
    v_mov_b32 v68, v1
    v_perm_b32 v1, v71, v69, s94
    v_perm_b32 v71, v71, v69, s95
    v_mov_b32 v69, v1
    v_perm_b32 v1, v74, v72, s94
    v_perm_b32 v74, v74, v72, s95
    v_mov_b32 v72, v1
    v_perm_b32 v1, v75, v73, s94
    v_perm_b32 v75, v75, v73, s95
    v_mov_b32 v73, v1
    v_perm_b32 v1, v78, v76, s94
    v_perm_b32 v78, v78, v76, s95
    v_mov_b32 v76, v1
    v_perm_b32 v1, v79, v77, s94
    v_perm_b32 v79, v79, v77, s95
    v_mov_b32 v77, v1
    v_perm_b32 v1, v82, v80, s94
    v_perm_b32 v82, v82, v80, s95
    v_mov_b32 v80, v1
    v_perm_b32 v1, v83, v81, s94
    v_perm_b32 v83, v83, v81, s95
    v_mov_b32 v81, v1
    v_perm_b32 v1, v86, v84, s94
    v_perm_b32 v86, v86, v84, s95
    v_mov_b32 v84, v1
    v_perm_b32 v1, v87, v85, s94
    v_perm_b32 v87, v87, v85, s95
    v_mov_b32 v85, v1
    s_barrier
    s_branch L_S4PRE
L_P3A:
    ds_read_b64 v[20:21], v13 offset:0
    ds_read_b64 v[22:23], v13 offset:8
    ds_read_b64 v[24:25], v13 offset:16
    ds_read_b64 v[26:27], v13 offset:24
    ds_read_b64 v[28:29], v13 offset:32
    v_lshlrev_b32 v5, 4, v2
    v_lshl_add_u32 v5, v3, 2, v5
    s_lshl_b32 s84, s81, 10
    s_lshl_b32 s85, s77, 8
    s_add_u32 s85, s85, 2621440
    s_add_u32 s84, s84, s85
    v_cmp_gt_u32 vcc, 32, v0
    s_barrier
    ds_read_b128 v[32:35], v6 offset:0
    ds_read_b128 v[36:39], v6 offset:1024
    ds_read_b128 v[40:43], v6 offset:2048
    ds_read_b128 v[44:47], v6 offset:3072
    ds_read_b128 v[48:51], v6 offset:4096
    s_waitcnt lgkmcnt(4)
    v_pk_add_f32 v[64:65], v[64:65], v[32:33]
    v_pk_add_f32 v[66:67], v[66:67], v[34:35]
    v_cvt_pk_bf16_f32 v52, v64, v65
    v_cvt_pk_bf16_f32 v53, v66, v67
    v_dot2_f32_bf16 v84, v52, s83, 0
    v_dot2_f32_bf16 v85, v52, v52, 0
    v_dot2_f32_bf16 v86, v52, v20, 0
    v_dot2_f32_bf16 v84, v53, s83, v84
    v_dot2_f32_bf16 v85, v53, v53, v85
    v_dot2_f32_bf16 v86, v53, v21, v86
    s_waitcnt lgkmcnt(3)
    v_pk_add_f32 v[68:69], v[68:69], v[36:37]
    v_pk_add_f32 v[70:71], v[70:71], v[38:39]
    v_cvt_pk_bf16_f32 v54, v68, v69
    v_cvt_pk_bf16_f32 v55, v70, v71
    v_dot2_f32_bf16 v84, v54, s83, v84
    v_dot2_f32_bf16 v85, v54, v54, v85
    v_dot2_f32_bf16 v86, v54, v22, v86
    v_dot2_f32_bf16 v84, v55, s83, v84
    v_dot2_f32_bf16 v85, v55, v55, v85
    v_dot2_f32_bf16 v86, v55, v23, v86
    s_waitcnt lgkmcnt(2)
    v_pk_add_f32 v[72:73], v[72:73], v[40:41]
    v_pk_add_f32 v[74:75], v[74:75], v[42:43]
    v_cvt_pk_bf16_f32 v56, v72, v73
    v_cvt_pk_bf16_f32 v57, v74, v75
    v_dot2_f32_bf16 v84, v56, s83, v84
    v_dot2_f32_bf16 v85, v56, v56, v85
    v_dot2_f32_bf16 v86, v56, v24, v86
    v_dot2_f32_bf16 v84, v57, s83, v84
    v_dot2_f32_bf16 v85, v57, v57, v85
    v_dot2_f32_bf16 v86, v57, v25, v86
    s_waitcnt lgkmcnt(1)
    v_pk_add_f32 v[76:77], v[76:77], v[44:45]
    v_pk_add_f32 v[78:79], v[78:79], v[46:47]
    v_cvt_pk_bf16_f32 v58, v76, v77
    v_cvt_pk_bf16_f32 v59, v78, v79
    v_dot2_f32_bf16 v84, v58, s83, v84
    v_dot2_f32_bf16 v85, v58, v58, v85
    v_dot2_f32_bf16 v86, v58, v26, v86
    v_dot2_f32_bf16 v84, v59, s83, v84
    v_dot2_f32_bf16 v85, v59, v59, v85
    v_dot2_f32_bf16 v86, v59, v27, v86
    s_waitcnt lgkmcnt(0)
    v_pk_add_f32 v[80:81], v[80:81], v[48:49]
    v_pk_add_f32 v[82:83], v[82:83], v[50:51]
    v_cvt_pk_bf16_f32 v60, v80, v81
    v_cndmask_b32 v60, 0, v60, vcc
    v_cvt_pk_bf16_f32 v61, v82, v83
    v_cndmask_b32 v61, 0, v61, vcc
    v_dot2_f32_bf16 v84, v60, s83, v84
    v_dot2_f32_bf16 v85, v60, v60, v85
    v_dot2_f32_bf16 v86, v60, v28, v86
    v_dot2_f32_bf16 v84, v61, s83, v84
    v_dot2_f32_bf16 v85, v61, v61, v85
    v_dot2_f32_bf16 v86, v61, v29, v86
    v_mov_b32 v87, v19
    s_nop 1
    v_permlane32_swap_b32 v84, v86
    v_permlane32_swap_b32 v85, v87
    v_add_f32 v84, v84, v86
    v_add_f32 v85, v85, v87
    s_nop 1
    v_permlane16_swap_b32 v84, v85
    v_add_f32 v84, v84, v85
    s_cmp_eq_u32 s88, 0
    s_cbranch_scc1 L_STW
    buffer_store_dword v84, v5, s[68:71], s84 offen
    s_branch L_STX
L_STW:
    buffer_store_dword v84, v5, s[68:71], s84 offen sc1
L_STX:
    s_lshl_b32 s30, s79, 13
    s_add_u32 s30, s30, s85
    v_lshlrev_b32 v6, 11, v3
    v_lshl_add_u32 v6, v2, 4, v6
    v_lshlrev_b32 v64, 16, v52
    v_and_b32 v65, 0xffff0000, v52
    v_lshlrev_b32 v66, 16, v53
    v_and_b32 v67, 0xffff0000, v53
    v_lshlrev_b32 v68, 16, v54
    v_and_b32 v69, 0xffff0000, v54
    v_lshlrev_b32 v70, 16, v55
    v_and_b32 v71, 0xffff0000, v55
    v_lshlrev_b32 v72, 16, v56
    v_and_b32 v73, 0xffff0000, v56
    v_lshlrev_b32 v74, 16, v57
    v_and_b32 v75, 0xffff0000, v57
    v_lshlrev_b32 v76, 16, v58
    v_and_b32 v77, 0xffff0000, v58
    v_lshlrev_b32 v78, 16, v59
    v_and_b32 v79, 0xffff0000, v59
    v_lshlrev_b32 v80, 16, v60
    v_and_b32 v81, 0xffff0000, v60
    v_lshlrev_b32 v82, 16, v61
    v_and_b32 v83, 0xffff0000, v61
    s_mul_i32 s84, s76, 6912
    s_cmp_ge_u32 s76, 6
    s_cselect_b32 s94, 41472, 0
    s_add_u32 s84, s84, s94
    v_mul_u32_u24 v5, 864, v3
    v_cmp_gt_u32 vcc, 8, v2
    s_nop 1
    v_cndmask_b32 v1, 11, v2, vcc
    v_lshl_add_u32 v5, v1, 2, v5
    v_add_u32 v5, s84, v5
    s_mov_b32 s94, 0x05040100
    s_mov_b32 s95, 0x07060302
    ds_read_b32 v92, v5 offset:0
    ds_read_b32 v93, v5 offset:48
    ds_read_b32 v94, v5 offset:96
    ds_read_b32 v95, v5 offset:144
    ds_read_b32 v96, v5 offset:192
    ds_read_b32 v97, v5 offset:240
    ds_read_b32 v98, v5 offset:288
    ds_read_b32 v99, v5 offset:336
    ds_read_b32 v100, v5 offset:384
    ds_read_b32 v101, v5 offset:432
    ds_read_b32 v102, v5 offset:480
    ds_read_b32 v103, v5 offset:528
    s_waitcnt lgkmcnt(4)
    ds_read_b32 v104, v5 offset:576
    ds_read_b32 v105, v5 offset:624
    ds_read_b32 v106, v5 offset:672
    ds_read_b32 v107, v5 offset:720
    ds_read_b32 v108, v5 offset:768
    ds_read_b32 v109, v5 offset:816
    buffer_load_dwordx4 v[84:87], v6, s[68:71], s30 offen sc1
    buffer_load_dwordx4 v[88:91], v6, s[68:71], s30 offen offset:1024 sc1
    s_waitcnt lgkmcnt(0)
    v_perm_b32 v1, v93, v92, s94
    v_perm_b32 v93, v93, v92, s95
    v_mov_b32 v92, v1
    v_perm_b32 v1, v95, v94, s94
    v_perm_b32 v95, v95, v94, s95
    v_mov_b32 v94, v1
    v_perm_b32 v1, v97, v96, s94
    v_perm_b32 v97, v97, v96, s95
    v_mov_b32 v96, v1
    v_perm_b32 v1, v99, v98, s94
    v_perm_b32 v99, v99, v98, s95
    v_mov_b32 v98, v1
    v_perm_b32 v1, v101, v100, s94
    v_perm_b32 v101, v101, v100, s95
    v_mov_b32 v100, v1
    v_perm_b32 v1, v103, v102, s94
    v_perm_b32 v103, v103, v102, s95
    v_mov_b32 v102, v1
    v_perm_b32 v1, v105, v104, s94
    v_perm_b32 v105, v105, v104, s95
    v_mov_b32 v104, v1
    v_perm_b32 v1, v107, v106, s94
    v_perm_b32 v107, v107, v106, s95
    v_mov_b32 v106, v1
    v_perm_b32 v1, v109, v108, s94
    v_perm_b32 v109, v109, v108, s95
    v_mov_b32 v108, v1
    s_waitcnt vmcnt(0)
    v_max3_u32 v7, v84, v85, v86
    v_max3_u32 v8, v87, v88, v89
    v_max3_u32 v7, v90, v91, v7
    v_max_u32 v7, v8, v7
    v_cmp_eq_u32 vcc, -1, v7
    s_cbranch_vccz L_S3OK
    s_mov_b32 s89, 0
L_S3:
    buffer_load_dwordx4 v[84:87], v6, s[68:71], s30 offen sc1
    buffer_load_dwordx4 v[88:91], v6, s[68:71], s30 offen offset:1024 sc1
    s_waitcnt vmcnt(0)
    v_max3_u32 v7, v84, v85, v86
    v_max3_u32 v8, v87, v88, v89
    v_max3_u32 v7, v90, v91, v7
    v_max_u32 v7, v8, v7
    v_cmp_eq_u32 vcc, -1, v7
    s_cbranch_vccz L_S3OK
    s_add_u32 s89, s89, 1
    s_cmp_lt_u32 s89, 20000
    s_cbranch_scc1 L_S3
L_S3OK:
    v_pk_add_f32 v[84:85], v[84:85], v[88:89]
    v_pk_add_f32 v[86:87], v[86:87], v[90:91]
    s_nop 1
    v_permlane32_swap_b32 v84, v86
    v_permlane32_swap_b32 v85, v87
    v_add_f32 v84, v84, v86
    v_add_f32 v85, v85, v87
    v_mov_b32 v86, v84
    v_mov_b32 v87, v85
    s_nop 0
    v_permlane16_swap_b32 v84, v86
    v_permlane16_swap_b32 v85, v87
    v_add_f32 v84, v84, v86
    v_add_f32 v85, v85, v87
    v_mov_b32 v86, v84
    v_mov_b32 v87, v85
    s_nop 0
    v_permlane32_swap_b32 v84, v86
    v_permlane32_swap_b32 v85, v87
    v_mul_f32 v88, 0x3ae38e39, v84
    v_mul_f32 v89, 0x3ae38e39, v85
    v_fma_f32 v90, -v88, v88, v89
    v_max_f32 v90, 0, v90
    v_cvt_pk_bf16_f32 v90, v90, v88
    v_and_b32 v88, 0xffff0000, v90
    v_lshlrev_b32 v90, 16, v90
    v_add_f32 v90, 0x3727c5ac, v90
    v_cvt_pk_bf16_f32 v90, v90, v90
    v_lshlrev_b32 v90, 16, v90
    v_sqrt_f32 v90, v90
    s_nop 0
    v_cvt_pk_bf16_f32 v90, v90, v90
    v_lshlrev_b32 v90, 16, v90
    v_rcp_f32 v89, v90
    v_fma_f32 v90, -v88, v87, v86
    s_lshl_b32 s84, s77, 4
    s_sub_u32 s84, 63, s84
    v_mul_f32 v90, v90, v89
    v_sub_u32 v30, s84, v2
    v_ashrrev_i32 v31, 31, v90
    v_mov_b32 v6, 159752
    v_or_b32 v31, 0x80000000, v31
    v_xor_b32 v31, v31, v90
    s_mov_b64 exec, 0xffff
    ds_max_u64 v6, v[30:31]
    s_mov_b64 exec, -1
    v_sub_f32 v62, v64, v88
    v_sub_f32 v63, v65, v88
    v_cvt_pk_bf16_f32 v62, v62, v63
    v_and_b32 v63, 0xffff0000, v62
    v_lshlrev_b32 v62, 16, v62
    v_mul_f32 v62, v62, v89
    v_mul_f32 v63, v63, v89
    v_cvt_pk_bf16_f32 v32, v62, v63
    v_sub_f32 v62, v66, v88
    v_sub_f32 v63, v67, v88
    v_cvt_pk_bf16_f32 v62, v62, v63
    v_and_b32 v63, 0xffff0000, v62
    v_lshlrev_b32 v62, 16, v62
    v_mul_f32 v62, v62, v89
    v_mul_f32 v63, v63, v89
    v_cvt_pk_bf16_f32 v33, v62, v63
    s_waitcnt lgkmcnt(0)
    s_barrier
    ds_read_b64 v[30:31], v6
    v_sub_f32 v62, v68, v88
    v_sub_f32 v63, v69, v88
    v_cvt_pk_bf16_f32 v62, v62, v63
    v_and_b32 v63, 0xffff0000, v62
    v_lshlrev_b32 v62, 16, v62
    v_mul_f32 v62, v62, v89
    v_mul_f32 v63, v63, v89
    v_cvt_pk_bf16_f32 v34, v62, v63
    v_sub_f32 v62, v70, v88
    v_sub_f32 v63, v71, v88
    v_cvt_pk_bf16_f32 v62, v62, v63
    v_and_b32 v63, 0xffff0000, v62
    v_lshlrev_b32 v62, 16, v62
    v_mul_f32 v62, v62, v89
    v_mul_f32 v63, v63, v89
    v_cvt_pk_bf16_f32 v35, v62, v63
    s_waitcnt lgkmcnt(0)
    v_readfirstlane_b32 s92, v30
    s_lshl_b32 s85, s77, 4
    v_add_u32 v6, s85, v2
    s_sub_u32 s92, 63, s92
    s_lshl_b32 s84, s79, 6
    s_add_u32 s84, s84, s92
    v_cmp_eq_u32 s[86:87], s92, v6
    s_lshl_b32 s85, s81, 9
    s_add_u32 s85, s85, 2883584
    v_mov_b32 v30, s84
    v_mov_b32 v7, 2146435072
    v_lshlrev_b32 v6, 3, v3
    v_cndmask_b32 v6, v7, v6, s[86:87]
    s_cmp_lg_u32 s80, 0
    s_cbranch_scc1 L_NOHDR
    v_cmp_eq_u32 vcc, 0, v6
    s_nop 1
    v_cndmask_b32 v8, v7, v6, vcc
    buffer_store_dwordx2 v[30:31], v8, s[68:71], s85 offen sc1
L_NOHDR:
    v_cmp_gt_u32 vcc, 32, v0
    s_nop 1
    v_cndmask_b32 v5, v7, v6, vcc
    v_sub_f32 v62, v72, v88
    v_sub_f32 v63, v73, v88
    v_cvt_pk_bf16_f32 v62, v62, v63
    v_and_b32 v63, 0xffff0000, v62
    v_lshlrev_b32 v62, 16, v62
    v_mul_f32 v62, v62, v89
    v_mul_f32 v63, v63, v89
    v_cvt_pk_bf16_f32 v36, v62, v63
    v_sub_f32 v62, v74, v88
    v_sub_f32 v63, v75, v88
    v_cvt_pk_bf16_f32 v62, v62, v63
    v_and_b32 v63, 0xffff0000, v62
    v_lshlrev_b32 v62, 16, v62
    v_mul_f32 v62, v62, v89
    v_mul_f32 v63, v63, v89
    v_cvt_pk_bf16_f32 v37, v62, v63
    v_sub_f32 v62, v76, v88
    v_sub_f32 v63, v77, v88
    v_cvt_pk_bf16_f32 v62, v62, v63
    v_and_b32 v63, 0xffff0000, v62
    v_lshlrev_b32 v62, 16, v62
    v_mul_f32 v62, v62, v89
    v_mul_f32 v63, v63, v89
    v_cvt_pk_bf16_f32 v38, v62, v63
    v_sub_f32 v62, v78, v88
    v_sub_f32 v63, v79, v88
    v_cvt_pk_bf16_f32 v62, v62, v63
    v_and_b32 v63, 0xffff0000, v62
    v_lshlrev_b32 v62, 16, v62
    v_mul_f32 v62, v62, v89
    v_mul_f32 v63, v63, v89
    v_cvt_pk_bf16_f32 v39, v62, v63
    v_sub_f32 v62, v80, v88
    v_sub_f32 v63, v81, v88
    v_cvt_pk_bf16_f32 v62, v62, v63
    v_and_b32 v63, 0xffff0000, v62
    v_lshlrev_b32 v62, 16, v62
    v_mul_f32 v62, v62, v89
    v_mul_f32 v63, v63, v89
    v_cvt_pk_bf16_f32 v40, v62, v63
    v_sub_f32 v62, v82, v88
    v_sub_f32 v63, v83, v88
    v_cvt_pk_bf16_f32 v62, v62, v63
    v_and_b32 v63, 0xffff0000, v62
    v_lshlrev_b32 v62, 16, v62
    v_mul_f32 v62, v62, v89
    v_mul_f32 v63, v63, v89
    v_cvt_pk_bf16_f32 v41, v62, v63
    s_lshr_b32 s84, s92, 4
    s_cmp_lg_u32 s84, s77
    s_cbranch_scc1 L_NOREC
    buffer_store_dwordx2 v[32:33], v6, s[68:71], s85 offen offset:128 sc1
    buffer_store_dwordx2 v[34:35], v6, s[68:71], s85 offen offset:160 sc1
    buffer_store_dwordx2 v[36:37], v6, s[68:71], s85 offen offset:192 sc1
    buffer_store_dwordx2 v[38:39], v6, s[68:71], s85 offen offset:224 sc1
    buffer_store_dwordx2 v[40:41], v5, s[68:71], s85 offen offset:256 sc1
    buffer_store_dwordx2 v[52:53], v6, s[68:71], s85 offen offset:272 sc1
    buffer_store_dwordx2 v[54:55], v6, s[68:71], s85 offen offset:304 sc1
    buffer_store_dwordx2 v[56:57], v6, s[68:71], s85 offen offset:336 sc1
    buffer_store_dwordx2 v[58:59], v6, s[68:71], s85 offen offset:368 sc1
    buffer_store_dwordx2 v[60:61], v5, s[68:71], s85 offen offset:400 sc1
L_NOREC:
    v_lshlrev_b32 v62, 16, v32
    v_and_b32 v63, 0xffff0000, v32
    v_pk_add_f32 v[62:63], v[62:63], v[64:65]
    v_cvt_pk_bf16_f32 v42, v62, v63
    v_lshlrev_b32 v62, 16, v33
    v_and_b32 v63, 0xffff0000, v33
    v_pk_add_f32 v[62:63], v[62:63], v[66:67]
    v_cvt_pk_bf16_f32 v43, v62, v63
    v_lshlrev_b32 v62, 16, v34
    v_and_b32 v63, 0xffff0000, v34
    v_pk_add_f32 v[62:63], v[62:63], v[68:69]
    v_cvt_pk_bf16_f32 v44, v62, v63
    v_lshlrev_b32 v62, 16, v35
    v_and_b32 v63, 0xffff0000, v35
    v_pk_add_f32 v[62:63], v[62:63], v[70:71]
    v_cvt_pk_bf16_f32 v45, v62, v63
    v_lshlrev_b32 v62, 16, v36
    v_and_b32 v63, 0xffff0000, v36
    v_pk_add_f32 v[62:63], v[62:63], v[72:73]
    v_cvt_pk_bf16_f32 v46, v62, v63
    v_lshlrev_b32 v62, 16, v37
    v_and_b32 v63, 0xffff0000, v37
    v_pk_add_f32 v[62:63], v[62:63], v[74:75]
    v_cvt_pk_bf16_f32 v47, v62, v63
    v_lshlrev_b32 v62, 16, v38
    v_and_b32 v63, 0xffff0000, v38
    v_pk_add_f32 v[62:63], v[62:63], v[76:77]
    v_cvt_pk_bf16_f32 v48, v62, v63
    v_lshlrev_b32 v62, 16, v39
    v_and_b32 v63, 0xffff0000, v39
    v_pk_add_f32 v[62:63], v[62:63], v[78:79]
    v_cvt_pk_bf16_f32 v49, v62, v63
    v_lshlrev_b32 v62, 16, v40
    v_and_b32 v63, 0xffff0000, v40
    v_pk_add_f32 v[62:63], v[62:63], v[80:81]
    v_cvt_pk_bf16_f32 v50, v62, v63
    v_lshlrev_b32 v62, 16, v41
    v_and_b32 v63, 0xffff0000, v41
    v_pk_add_f32 v[62:63], v[62:63], v[82:83]
    v_cvt_pk_bf16_f32 v51, v62, v63
    v_permlane16_swap_b32 v42, v44
    v_permlane16_swap_b32 v43, v45
    v_permlane16_swap_b32 v46, v48
    v_permlane16_swap_b32 v47, v49
    s_lshl_b32 s30, s79, 2
    s_add_u32 s30, s30, s77
    s_mul_i32 s30, s30, 18432
    s_mul_i32 s31, s80, 144
    s_add_u32 s93, s30, s31
    v_mul_u32_u24 v5, 1152, v2
    v_and_b32 v6, 1, v3
    v_lshrrev_b32 v8, 1, v3
    v_lshl_add_u32 v17, v6, 5, v5
    v_lshl_add_u32 v17, v8, 4, v17
    v_lshl_add_u32 v18, v3, 3, v5
    v_cndmask_b32 v18, v7, v18, vcc
    v_cndmask_b32 v5, v17, v7, s[86:87]
    v_cndmask_b32 v6, v18, v7, s[86:87]
    buffer_store_dwordx4 v[42:45], v5, s[64:67], s93 offen
    buffer_store_dwordx4 v[46:49], v5, s[64:67], s93 offen offset:64
    buffer_store_dwordx2 v[50:51], v6, s[64:67], s93 offen offset:128
    v_cndmask_b32 v17, v7, v17, s[86:87]
    v_cndmask_b32 v18, v7, v18, s[86:87]
    s_mul_i32 s84, s76, 6912
    s_cmp_ge_u32 s76, 6
    s_cselect_b32 s94, 41472, 0
    s_add_u32 s84, s84, s94
    v_mul_u32_u24 v5, 864, v3
    v_cmp_gt_u32 vcc, 8, v2
    s_nop 1
    v_cndmask_b32 v1, 11, v2, vcc
    v_lshl_add_u32 v5, v1, 2, v5
    v_add_u32 v5, s84, v5
    s_mov_b32 s94, 0x05040100
    s_mov_b32 s95, 0x07060302
    ds_read_b32 v110, v5 offset:3456
    ds_read_b32 v111, v5 offset:3504
    ds_read_b32 v112, v5 offset:3552
    ds_read_b32 v113, v5 offset:3600
    ds_read_b32 v114, v5 offset:3648
    ds_read_b32 v115, v5 offset:3696
    ds_read_b32 v116, v5 offset:3744
    ds_read_b32 v117, v5 offset:3792
    ds_read_b32 v118, v5 offset:3840
    ds_read_b32 v119, v5 offset:3888
    ds_read_b32 v120, v5 offset:3936
    ds_read_b32 v121, v5 offset:3984
    s_waitcnt lgkmcnt(4)
    ds_read_b32 v122, v5 offset:4032
    ds_read_b32 v123, v5 offset:4080
    ds_read_b32 v124, v5 offset:4128
    ds_read_b32 v125, v5 offset:4176
    ds_read_b32 v126, v5 offset:4224
    ds_read_b32 v127, v5 offset:4272
    s_waitcnt lgkmcnt(0)
    v_perm_b32 v1, v111, v110, s94
    v_perm_b32 v111, v111, v110, s95
    v_mov_b32 v110, v1
    v_perm_b32 v1, v113, v112, s94
    v_perm_b32 v113, v113, v112, s95
    v_mov_b32 v112, v1
    v_perm_b32 v1, v115, v114, s94
    v_perm_b32 v115, v115, v114, s95
    v_mov_b32 v114, v1
    v_perm_b32 v1, v117, v116, s94
    v_perm_b32 v117, v117, v116, s95
    v_mov_b32 v116, v1
    v_perm_b32 v1, v119, v118, s94
    v_perm_b32 v119, v119, v118, s95
    v_mov_b32 v118, v1
    v_perm_b32 v1, v121, v120, s94
    v_perm_b32 v121, v121, v120, s95
    v_mov_b32 v120, v1
    v_perm_b32 v1, v123, v122, s94
    v_perm_b32 v123, v123, v122, s95
    v_mov_b32 v122, v1
    v_perm_b32 v1, v125, v124, s94
    v_perm_b32 v125, v125, v124, s95
    v_mov_b32 v124, v1
    v_perm_b32 v1, v127, v126, s94
    v_perm_b32 v127, v127, v126, s95
    v_mov_b32 v126, v1
L_S4PRE:
    v_mov_b32 v8, 159856
    s_cmp_lg_u32 s76, 1
    s_cbranch_scc1 L_S4W
    v_and_b32 v5, 31, v0
    v_lshlrev_b32 v5, 12, v5
    v_mul_u32_u24 v6, 7282, v0
    v_lshrrev_b32 v6, 16, v6
    v_mul_u32_u24 v7, 9, v6
    v_sub_u32 v7, v0, v7
    v_lshlrev_b32 v6, 9, v6
    v_lshl_add_u32 v6, v7, 4, v6
    v_lshlrev_b32 v9, 4, v0
    v_add_u32 v7, 3600, v9
    v_cmp_gt_u32 vcc, 8, v0
    v_mov_b32 v28, 2146435072
    s_nop 0
    v_cndmask_b32 v7, v28, v7, vcc
    v_add_u32 v9, 162304, v9
    v_mov_b32 v28, 159752
    ds_read_b64 v[34:35], v28
    v_and_b32 v28, 31, v0
    v_cmp_eq_u32 s[100:101], s79, v28
    s_lshl_b32 s30, s79, 6
    s_add_u32 s30, s30, 63
    s_waitcnt lgkmcnt(0)
    v_sub_u32 v34, s30, v34
    s_mov_b32 s30, 2883584
    s_mov_b32 s31, s79
    s_mov_b32 s89, 0
L_S4:
    s_lshl_b32 s84, s31, 12
    s_add_u32 s84, s84, 2883712
    buffer_load_dwordx2 v[30:31], v5, s[68:71], s30 offen sc1
    buffer_load_dwordx4 v[20:23], v6, s[68:71], s84 offen sc1
    buffer_load_dwordx4 v[24:27], v7, s[68:71], s84 offen sc1
L_S4M:
    s_waitcnt vmcnt(2)
    v_cndmask_b32 v30, v30, v34, s[100:101]
    v_cndmask_b32 v31, v31, v35, s[100:101]
    v_cmp_eq_u32 s[98:99], -1, v30
    s_nop 1
    v_cndmask_b32 v31, v31, 0, s[98:99]
    v_mov_b32 v32, v31
    s_nop 1
    v_mov_b32_dpp v33, v32 row_ror:8 row_mask:0xf bank_mask:0xf
    v_max_u32 v32, v32, v33
    s_nop 1
    v_mov_b32_dpp v33, v32 row_ror:4 row_mask:0xf bank_mask:0xf
    v_max_u32 v32, v32, v33
    s_nop 1
    v_mov_b32_dpp v33, v32 row_ror:2 row_mask:0xf bank_mask:0xf
    v_max_u32 v32, v32, v33
    s_nop 1
    v_mov_b32_dpp v33, v32 row_ror:1 row_mask:0xf bank_mask:0xf
    v_max_u32 v32, v32, v33
    v_mov_b32 v33, v32
    s_nop 1
    v_permlane16_swap_b32 v32, v33
    v_max_u32 v32, v32, v33
    v_cmp_eq_u32 vcc, v31, v32
    s_nop 0
    s_ff1_i32_b64 s97, vcc
    s_waitcnt vmcnt(0)
    v_max3_u32 v28, v20, v21, v22
    v_max3_u32 v29, v23, v24, v25
    v_max3_u32 v28, v26, v27, v28
    v_max_u32 v28, v28, v29
    v_cmp_eq_u32 vcc, -1, v28
    s_nop 0
    s_or_b64 vcc, vcc, s[98:99]
    s_cmp_lg_u32 s97, s31
    s_cselect_b64 vcc, -1, vcc
    s_mov_b32 s31, s97
    s_cbranch_vccz L_S4OK
    s_add_u32 s89, s89, 1
    s_cmp_lt_u32 s89, 20000
    s_cbranch_scc1 L_S4
L_S4OK:
    ds_write_b128 v9, v[20:23]
    s_lshl_b64 exec, 1, s97
    ds_write_b64 v8, v[30:31]
    s_mov_b64 exec, 0xff
    ds_write_b128 v9, v[24:27] offset:1024
    s_mov_b64 exec, -1
L_S4W:
    v_mul_u32_u24 v6, 36, v3
    s_mul_i32 s84, s76, 144
    s_add_u32 s84, s84, 162304
    v_add_u32 v6, s84, v6
    v_lshlrev_b32 v7, 1, v0
    s_lshl_b32 s30, s81, 4
    v_add_u32 v7, s30, v7
    v_mul_u32_u24 v5, 911, v7
    v_lshrrev_b32 v5, 16, v5
    v_mul_u32_u24 v9, 368, v5
    v_lshl_add_u32 v14, v7, 1, v9
    v_cmp_gt_u32 vcc, 8, v0
    v_mov_b32 v9, 2146435072
    s_nop 0
    v_cndmask_b32 v14, v9, v14, vcc
    s_waitcnt lgkmcnt(0)
    s_barrier
    ds_read2_b32 v[20:21], v6 offset0:0 offset1:1
    ds_read2_b32 v[22:23], v6 offset0:2 offset1:3
    ds_read2_b32 v[24:25], v6 offset0:4 offset1:5
    ds_read2_b32 v[26:27], v6 offset0:6 offset1:7
    ds_read_b32 v28, v6 offset:32
    ds_read_b64 v[34:35], v8
    s_waitcnt lgkmcnt(1)
    v_dot2_f32_bf16 v30, v92, v20, 0
    v_dot2_f32_bf16 v31, v93, v20, 0
    v_dot2_f32_bf16 v32, v110, v20, 0
    v_dot2_f32_bf16 v33, v111, v20, 0
    v_dot2_f32_bf16 v30, v94, v21, v30
    v_dot2_f32_bf16 v31, v95, v21, v31
    v_dot2_f32_bf16 v32, v112, v21, v32
    v_dot2_f32_bf16 v33, v113, v21, v33
    v_dot2_f32_bf16 v30, v96, v22, v30
    v_dot2_f32_bf16 v31, v97, v22, v31
    v_dot2_f32_bf16 v32, v114, v22, v32
    v_dot2_f32_bf16 v33, v115, v22, v33
    v_dot2_f32_bf16 v30, v98, v23, v30
    v_dot2_f32_bf16 v31, v99, v23, v31
    v_dot2_f32_bf16 v32, v116, v23, v32
    v_dot2_f32_bf16 v33, v117, v23, v33
    v_dot2_f32_bf16 v30, v100, v24, v30
    v_dot2_f32_bf16 v31, v101, v24, v31
    v_dot2_f32_bf16 v32, v118, v24, v32
    v_dot2_f32_bf16 v33, v119, v24, v33
    v_dot2_f32_bf16 v30, v102, v25, v30
    v_dot2_f32_bf16 v31, v103, v25, v31
    v_dot2_f32_bf16 v32, v120, v25, v32
    v_dot2_f32_bf16 v33, v121, v25, v33
    v_dot2_f32_bf16 v30, v104, v26, v30
    v_dot2_f32_bf16 v31, v105, v26, v31
    v_dot2_f32_bf16 v32, v122, v26, v32
    v_dot2_f32_bf16 v33, v123, v26, v33
    v_dot2_f32_bf16 v30, v106, v27, v30
    v_dot2_f32_bf16 v31, v107, v27, v31
    v_dot2_f32_bf16 v32, v124, v27, v32
    v_dot2_f32_bf16 v33, v125, v27, v33
    v_dot2_f32_bf16 v30, v108, v28, v30
    v_dot2_f32_bf16 v31, v109, v28, v31
    v_dot2_f32_bf16 v32, v126, v28, v32
    v_dot2_f32_bf16 v33, v127, v28, v33
    s_waitcnt lgkmcnt(0)
    v_readfirstlane_b32 s90, v34
    v_readfirstlane_b32 s91, v35
    s_and_b32 s90, s90, 2047
    v_lshlrev_b32 v6, 5, v2
    v_add_u32 v6, 160000, v6
    v_lshl_add_u32 v7, v3, 3, v6
    v_permlane32_swap_b32 v30, v32
    v_permlane32_swap_b32 v31, v33
    v_add_f32 v30, v30, v32
    v_add_f32 v31, v31, v33
    s_nop 1
    v_permlane16_swap_b32 v30, v31
    v_add_f32 v30, v30, v31
    v_cvt_f64_f32 v[30:31], v30
    ds_add_f64 v7, v[30:31]
    s_cmp_lg_u32 s78, 0
    s_cbranch_scc1 L_NOCAND
    s_lshl_b32 s84, s79, 6
    s_add_u32 s84, s84, s92
    s_cmp_eq_u32 s84, s90
    s_cbranch_scc1 L_NOCAND
    buffer_store_dwordx4 v[42:45], v17, s[64:67], s93 offen
    buffer_store_dwordx4 v[46:49], v17, s[64:67], s93 offen offset:64
    buffer_store_dwordx2 v[50:51], v18, s[64:67], s93 offen offset:128
L_NOCAND:
    s_waitcnt lgkmcnt(0)
    s_barrier
    s_cmp_eq_u32 s78, 0
    s_cbranch_scc1 L_RED
    ds_read_b128 v[20:23], v6
    ds_read_b128 v[24:27], v6 offset:16
    s_waitcnt lgkmcnt(0)
    v_cvt_f32_f64 v28, v[20:21]
    v_cvt_f32_f64 v29, v[22:23]
    v_cvt_f32_f64 v30, v[24:25]
    v_cvt_f32_f64 v31, v[26:27]
    v_cvt_pk_bf16_f32 v28, v28, v29
    v_cvt_pk_bf16_f32 v30, v30, v31
    v_and_b32 v29, 0xffff0000, v28
    v_lshlrev_b32 v28, 16, v28
    v_mul_f32 v33, 0xbfb8aa3b, v29
    v_mul_f32 v32, 0xbfb8aa3b, v28
    v_exp_f32 v33, v33
    v_exp_f32 v32, v32
    v_and_b32 v31, 0xffff0000, v30
    v_add_f32 v33, 1.0, v33
    v_add_f32 v32, 1.0, v32
    v_rcp_f32 v33, v33
    v_rcp_f32 v32, v32
    v_lshlrev_b32 v30, 16, v30
    v_mul_f32 v29, v29, v33
    v_mul_f32 v28, v28, v32
    v_cvt_pk_bf16_f32 v28, v28, v29
    v_and_b32 v29, 0xffff0000, v28
    v_lshlrev_b32 v28, 16, v28
    v_mul_f32 v29, v29, v31
    v_mul_f32 v28, v28, v30
    v_cvt_pk_bf16_f32 v28, v28, v29
    s_nop 0
    v_readlane_b32 s94, v28, 0
    v_readlane_b32 s95, v28, 1
    v_readlane_b32 s96, v28, 2
    v_readlane_b32 s97, v28, 3
    v_readlane_b32 s98, v28, 4
    v_readlane_b32 s99, v28, 5
    v_readlane_b32 s100, v28, 6
    v_readlane_b32 s101, v28, 7
    v_readlane_b32 s88, v28, 8
    v_dot2_f32_bf16 v32, v52, s94, 0
    v_dot2_f32_bf16 v33, v54, s94, 0
    v_dot2_f32_bf16 v34, v53, s94, 0
    v_dot2_f32_bf16 v35, v55, s94, 0
    v_dot2_f32_bf16 v32, v56, s95, v32
    v_dot2_f32_bf16 v33, v58, s95, v33
    v_dot2_f32_bf16 v34, v57, s95, v34
    v_dot2_f32_bf16 v35, v59, s95, v35
    v_dot2_f32_bf16 v32, v60, s96, v32
    v_dot2_f32_bf16 v33, v62, s96, v33
    v_dot2_f32_bf16 v34, v61, s96, v34
    v_dot2_f32_bf16 v35, v63, s96, v35
    v_dot2_f32_bf16 v32, v64, s97, v32
    v_dot2_f32_bf16 v33, v66, s97, v33
    v_dot2_f32_bf16 v34, v65, s97, v34
    v_dot2_f32_bf16 v35, v67, s97, v35
    v_dot2_f32_bf16 v32, v68, s98, v32
    v_dot2_f32_bf16 v33, v70, s98, v33
    v_dot2_f32_bf16 v34, v69, s98, v34
    v_dot2_f32_bf16 v35, v71, s98, v35
    v_dot2_f32_bf16 v32, v72, s99, v32
    v_dot2_f32_bf16 v33, v74, s99, v33
    v_dot2_f32_bf16 v34, v73, s99, v34
    v_dot2_f32_bf16 v35, v75, s99, v35
    v_dot2_f32_bf16 v32, v76, s100, v32
    v_dot2_f32_bf16 v33, v78, s100, v33
    v_dot2_f32_bf16 v34, v77, s100, v34
    v_dot2_f32_bf16 v35, v79, s100, v35
    v_dot2_f32_bf16 v32, v80, s101, v32
    v_dot2_f32_bf16 v33, v82, s101, v33
    v_dot2_f32_bf16 v34, v81, s101, v34
    v_dot2_f32_bf16 v35, v83, s101, v35
    v_dot2_f32_bf16 v32, v84, s88, v32
    v_dot2_f32_bf16 v33, v86, s88, v33
    v_dot2_f32_bf16 v34, v85, s88, v34
    v_dot2_f32_bf16 v35, v87, s88, v35
    s_nop 2
    buffer_store_dwordx4 v[32:35], v15, s[68:71], 0 offen sc1
L_RED:
    s_cmp_ge_u32 s81, 36
    s_cbranch_scc1 L_FIN
    s_lshl_b32 s84, s81, 14
    s_lshl_b32 s85, s76, 10
    s_add_u32 s84, s84, s85
    s_add_u32 s84, s84, 3145728
    s_add_u32 s85, s84, 8192
    v_lshlrev_b32 v6, 4, v0
    s_cmp_ge_u32 s91, 0x80000000
    s_cselect_b32 s30, 0x80000000, -1
    s_xor_b32 s30, s30, s91
    v_mov_b32 v38, s30
    s_cmp_lg_u32 s76, 0
    s_cbranch_scc1 L_HOK
    s_lshr_b32 s30, s90, 6
    s_lshl_b32 s30, s30, 12
    s_add_u32 s30, s30, 2883712
    s_mov_b32 s89, 0
L_HW:
    buffer_load_dword v36, v14, s[68:71], s30 offen sc1
    buffer_load_dword v37, v14, s[68:71], s30 offen offset:144 sc1
    s_waitcnt vmcnt(0)
    v_max_u32 v7, v36, v37
    v_cmp_eq_u32 vcc, -1, v7
    s_cbranch_vccz L_HOK
    s_add_u32 s89, s89, 1
    s_cmp_lt_u32 s89, 20000
    s_cbranch_scc1 L_HW
L_HOK:
    v_cvt_pk_bf16_f32 v38, v38, v38
    v_lshlrev_b32 v38, 16, v38
    v_mul_f32 v38, 0xbfb8aa3b, v38
    v_exp_f32 v38, v38
    s_nop 0
    v_add_f32 v38, 1.0, v38
    v_rcp_f32 v38, v38
    s_nop 0
    v_cvt_pk_bf16_f32 v38, v38, v38
    v_lshlrev_b32 v38, 16, v38
    v_and_b32 v33, 0xffff0000, v36
    v_lshlrev_b32 v32, 16, v36
    v_and_b32 v35, 0xffff0000, v37
    v_lshlrev_b32 v34, 16, v37
    v_and_b32 v9, 3, v0
    v_lshlrev_b32 v9, 5, v9
    v_lshl_add_u32 v9, v3, 3, v9
    v_add_u32 v9, 160512, v9
    v_and_b32 v10, 7, v0
    v_lshlrev_b32 v10, 4, v10
    v_add_u32 v10, 160512, v10
    s_mul_i32 s30, s90, 1152
    s_lshl_b32 s31, s81, 5
    s_add_u32 s30, s30, s31
    v_lshlrev_b32 v11, 2, v0
    v_cmp_gt_u32 vcc, 8, v0
    v_mov_b32 v7, 2146435072
    s_nop 0
    v_cndmask_b32 v11, v7, v11, vcc
    s_waitcnt vmcnt(0)
    s_barrier
    s_mov_b32 s89, 0
L_S5:
    buffer_load_dwordx4 v[20:23], v6, s[68:71], s84 offen sc1
    buffer_load_dwordx4 v[24:27], v6, s[68:71], s85 offen sc1
    s_waitcnt vmcnt(0)
    v_max3_u32 v7, v20, v21, v22
    v_max3_u32 v7, v23, v24, v7
    v_max3_u32 v7, v25, v26, v7
    v_max_u32 v7, v27, v7
    v_cmp_eq_u32 vcc, -1, v7
    s_cbranch_vccz L_S5OK
    s_add_u32 s89, s89, 1
    s_cmp_lt_u32 s89, 20000
    s_cbranch_scc1 L_S5
L_S5OK:
    v_pk_add_f32 v[20:21], v[20:21], v[24:25]
    v_pk_add_f32 v[22:23], v[22:23], v[26:27]
    s_nop 1
    v_permlane32_swap_b32 v20, v22
    v_permlane32_swap_b32 v21, v23
    v_add_f32 v20, v20, v22
    v_add_f32 v21, v21, v23
    s_nop 1
    v_permlane16_swap_b32 v20, v21
    v_add_f32 v20, v20, v21
    s_nop 1
    v_add_f32_dpp v20, v20, v20 row_ror:8 row_mask:0xf bank_mask:0xf
    s_mov_b32 s96, 0x000f000f
    s_mov_b32 s97, 0x000f000f
    v_add_f32_dpp v20, v20, v20 row_ror:4 row_mask:0xf bank_mask:0xf
    v_cvt_f64_f32 v[20:21], v20
    s_mov_b64 exec, s[96:97]
    ds_add_f64 v9, v[20:21]
    s_mov_b64 exec, -1
    s_waitcnt lgkmcnt(0)
    s_barrier
    s_cmp_lg_u32 s76, 0
    s_cbranch_scc1 L_FIN
    ds_read_b128 v[40:43], v10
    s_waitcnt lgkmcnt(0)
    v_cvt_f32_f64 v40, v[40:41]
    v_cvt_f32_f64 v41, v[42:43]
    v_cvt_pk_bf16_f32 v40, v40, v41
    v_and_b32 v41, 0xffff0000, v40
    v_lshlrev_b32 v40, 16, v40
    v_mul_f32 v40, v40, v38
    v_mul_f32 v41, v41, v38
    v_cvt_pk_bf16_f32 v40, v40, v41
    v_and_b32 v41, 0xffff0000, v40
    v_lshlrev_b32 v40, 16, v40
    v_pk_add_f32 v[40:41], v[40:41], v[32:33]
    v_cvt_pk_bf16_f32 v40, v40, v41
    v_and_b32 v41, 0xffff0000, v40
    v_lshlrev_b32 v40, 16, v40
    v_pk_add_f32 v[40:41], v[40:41], v[34:35]
    v_cvt_pk_bf16_f32 v40, v40, v41
    buffer_store_dword v40, v11, s[64:67], s30 offen
L_FIN:
L_END:
    s_endpgm
L_RT1:
    s_mov_b32 s89, 0
L_RT1S:
    s_sleep 1
    ds_read_b32 v1, v7 offset:2052
    s_waitcnt lgkmcnt(0)
    v_cmp_neq_f32 vcc, 1.0, v1
    s_mov_b32 vcc_lo, 0
    s_cbranch_vccz L_RT1D
    s_add_u32 s89, s89, 1
    s_cmp_lt_u32 s89, 20000
    s_cbranch_scc1 L_RT1S
L_RT1D:
    ds_read_b64 v[40:41], v7 offset:2048
    ds_read_b128 v[32:35], v7
    ds_read_b128 v[36:39], v7 offset:1024
    s_waitcnt lgkmcnt(0)
    s_branch L_RT1B
L_RT2:
    s_mov_b32 s89, 0
L_RT2S:
    s_sleep 1
    ds_read_b32 v1, v7 offset:2052
    s_waitcnt lgkmcnt(0)
    v_cmp_neq_f32 vcc, 2.0, v1
    s_mov_b32 vcc_lo, 0
    s_cbranch_vccz L_RT2D
    s_add_u32 s89, s89, 1
    s_cmp_lt_u32 s89, 20000
    s_cbranch_scc1 L_RT2S
L_RT2D:
    ds_read_b64 v[56:57], v7 offset:2048
    ds_read_b128 v[48:51], v7
    ds_read_b128 v[52:55], v7 offset:1024
    s_waitcnt lgkmcnt(0)
    s_branch L_RT2B
L_RT3:
    s_mov_b32 s89, 0
L_RT3S:
    s_sleep 1
    ds_read_b32 v1, v7 offset:2052
    s_waitcnt lgkmcnt(0)
    v_cmp_neq_f32 vcc, 4.0, v1
    s_mov_b32 vcc_lo, 0
    s_cbranch_vccz L_RT3D
    s_add_u32 s89, s89, 1
    s_cmp_lt_u32 s89, 20000
    s_cbranch_scc1 L_RT3S
L_RT3D:
    ds_read_b64 v[40:41], v7 offset:2048
    ds_read_b128 v[32:35], v7
    ds_read_b128 v[36:39], v7 offset:1024
    s_waitcnt lgkmcnt(0)
    s_branch L_RT3B
L_RT4:
    s_mov_b32 s89, 0
L_RT4S:
    s_sleep 1
    ds_read_b32 v1, v7 offset:2052
    s_waitcnt lgkmcnt(0)
    v_cmp_neq_f32 vcc, 0.5, v1
    s_mov_b32 vcc_lo, 0
    s_cbranch_vccz L_RT4D
    s_add_u32 s89, s89, 1
    s_cmp_lt_u32 s89, 20000
    s_cbranch_scc1 L_RT4S
L_RT4D:
    ds_read_b64 v[56:57], v7 offset:2048
    ds_read_b128 v[48:51], v7
    ds_read_b128 v[52:55], v7 offset:1024
    s_waitcnt lgkmcnt(0)
    s_branch L_RT4B
L_RT5:
    s_mov_b32 s89, 0
L_RT5S:
    s_sleep 1
    ds_read_b32 v1, v7 offset:2052
    s_waitcnt lgkmcnt(0)
    v_cmp_neq_f32 vcc, -1.0, v1
    s_mov_b32 vcc_lo, 0
    s_cbranch_vccz L_RT5D
    s_add_u32 s89, s89, 1
    s_cmp_lt_u32 s89, 20000
    s_cbranch_scc1 L_RT5S
L_RT5D:
    ds_read_b64 v[40:41], v7 offset:2048
    ds_read_b128 v[32:35], v7
    ds_read_b128 v[36:39], v7 offset:1024
    s_waitcnt lgkmcnt(0)
    s_branch L_RT5B
L_RT6:
    s_mov_b32 s89, 0
L_RT6S:
    s_sleep 1
    ds_read_b32 v1, v7 offset:2052
    s_waitcnt lgkmcnt(0)
    v_cmp_neq_f32 vcc, -2.0, v1
    s_mov_b32 vcc_lo, 0
    s_cbranch_vccz L_RT6D
    s_add_u32 s89, s89, 1
    s_cmp_lt_u32 s89, 20000
    s_cbranch_scc1 L_RT6S
L_RT6D:
    ds_read_b64 v[56:57], v7 offset:2048
    ds_read_b128 v[48:51], v7
    ds_read_b128 v[52:55], v7 offset:1024
    s_waitcnt lgkmcnt(0)
    s_branch L_RT6B
L_RT7:
    s_mov_b32 s89, 0
L_RT7S:
    s_sleep 1
    ds_read_b32 v1, v7 offset:2052
    s_waitcnt lgkmcnt(0)
    v_cmp_neq_f32 vcc, -4.0, v1
    s_mov_b32 vcc_lo, 0
    s_cbranch_vccz L_RT7D
    s_add_u32 s89, s89, 1
    s_cmp_lt_u32 s89, 20000
    s_cbranch_scc1 L_RT7S
L_RT7D:
    ds_read_b64 v[40:41], v7 offset:2048
    ds_read_b128 v[32:35], v7
    ds_read_b128 v[36:39], v7 offset:1024
    s_waitcnt lgkmcnt(0)
    s_branch L_RT7B
L_OR0:
    s_waitcnt vmcnt(0)
    s_mov_b32 s89, 0
L_OR0S:
    buffer_load_dwordx4 v[28:31], v8, s[68:71], s94 offen sc1
    s_waitcnt vmcnt(0)
    v_max3_u32 v7, v28, v29, v30
    v_max_u32 v7, v7, v31
    v_cmp_eq_u32 vcc, -1, v7
    s_cbranch_vccz L_OR0D
    s_add_u32 s89, s89, 1
    s_cmp_lt_u32 s89, 20000
    s_cbranch_scc1 L_OR0S
L_OR0D:
    buffer_load_dwordx4 v[32:35], v8, s[68:71], s95 offen sc1
    buffer_load_dwordx4 v[36:39], v8, s[68:71], s96 offen sc1
    buffer_load_dwordx4 v[40:43], v8, s[68:71], s97 offen sc1
    buffer_load_dwordx4 v[44:47], v8, s[68:71], s98 offen sc1
    s_branch L_OR0B
L_OR1:
    s_waitcnt vmcnt(0)
    s_mov_b32 s89, 0
L_OR1S:
    buffer_load_dwordx4 v[32:35], v8, s[68:71], s95 offen sc1
    s_waitcnt vmcnt(0)
    v_max3_u32 v7, v32, v33, v34
    v_max_u32 v7, v7, v35
    v_cmp_eq_u32 vcc, -1, v7
    s_cbranch_vccz L_OR1D
    s_add_u32 s89, s89, 1
    s_cmp_lt_u32 s89, 20000
    s_cbranch_scc1 L_OR1S
L_OR1D:
    buffer_load_dwordx4 v[36:39], v8, s[68:71], s96 offen sc1
    buffer_load_dwordx4 v[40:43], v8, s[68:71], s97 offen sc1
    buffer_load_dwordx4 v[44:47], v8, s[68:71], s98 offen sc1
    buffer_load_dwordx4 v[48:51], v8, s[68:71], s99 offen sc1
    s_branch L_OR1B
L_OR2:
    s_waitcnt vmcnt(0)
    s_mov_b32 s89, 0
L_OR2S:
    buffer_load_dwordx4 v[36:39], v8, s[68:71], s96 offen sc1
    s_waitcnt vmcnt(0)
    v_max3_u32 v7, v36, v37, v38
    v_max_u32 v7, v7, v39
    v_cmp_eq_u32 vcc, -1, v7
    s_cbranch_vccz L_OR2D
    s_add_u32 s89, s89, 1
    s_cmp_lt_u32 s89, 20000
    s_cbranch_scc1 L_OR2S
L_OR2D:
    buffer_load_dwordx4 v[40:43], v8, s[68:71], s97 offen sc1
    buffer_load_dwordx4 v[44:47], v8, s[68:71], s98 offen sc1
    buffer_load_dwordx4 v[48:51], v8, s[68:71], s99 offen sc1
    buffer_load_dwordx4 v[52:55], v8, s[68:71], s100 offen sc1
    s_branch L_OR2B
L_OR3:
    s_waitcnt vmcnt(0)
    s_mov_b32 s89, 0
L_OR3S:
    buffer_load_dwordx4 v[40:43], v8, s[68:71], s97 offen sc1
    s_waitcnt vmcnt(0)
    v_max3_u32 v7, v40, v41, v42
    v_max_u32 v7, v7, v43
    v_cmp_eq_u32 vcc, -1, v7
    s_cbranch_vccz L_OR3D
    s_add_u32 s89, s89, 1
    s_cmp_lt_u32 s89, 20000
    s_cbranch_scc1 L_OR3S
L_OR3D:
    buffer_load_dwordx4 v[44:47], v8, s[68:71], s98 offen sc1
    buffer_load_dwordx4 v[48:51], v8, s[68:71], s99 offen sc1
    buffer_load_dwordx4 v[52:55], v8, s[68:71], s100 offen sc1
    buffer_load_dwordx4 v[56:59], v8, s[68:71], s101 offen sc1
    s_branch L_OR3B
L_OR4:
    s_waitcnt vmcnt(0)
    s_mov_b32 s89, 0
L_OR4S:
    buffer_load_dwordx4 v[44:47], v8, s[68:71], s98 offen sc1
    s_waitcnt vmcnt(0)
    v_max3_u32 v7, v44, v45, v46
    v_max_u32 v7, v7, v47
    v_cmp_eq_u32 vcc, -1, v7
    s_cbranch_vccz L_OR4D
    s_add_u32 s89, s89, 1
    s_cmp_lt_u32 s89, 20000
    s_cbranch_scc1 L_OR4S
L_OR4D:
    buffer_load_dwordx4 v[48:51], v8, s[68:71], s99 offen sc1
    buffer_load_dwordx4 v[52:55], v8, s[68:71], s100 offen sc1
    buffer_load_dwordx4 v[56:59], v8, s[68:71], s101 offen sc1
    buffer_load_dwordx4 v[60:63], v8, s[68:71], s31 offen sc1
    s_branch L_OR4B
L_OR5:
    s_waitcnt vmcnt(0)
    s_mov_b32 s89, 0
L_OR5S:
    buffer_load_dwordx4 v[48:51], v8, s[68:71], s99 offen sc1
    s_waitcnt vmcnt(0)
    v_max3_u32 v7, v48, v49, v50
    v_max_u32 v7, v7, v51
    v_cmp_eq_u32 vcc, -1, v7
    s_cbranch_vccz L_OR5D
    s_add_u32 s89, s89, 1
    s_cmp_lt_u32 s89, 20000
    s_cbranch_scc1 L_OR5S
L_OR5D:
    buffer_load_dwordx4 v[52:55], v8, s[68:71], s100 offen sc1
    buffer_load_dwordx4 v[56:59], v8, s[68:71], s101 offen sc1
    buffer_load_dwordx4 v[60:63], v8, s[68:71], s31 offen sc1
    s_branch L_OR5B
L_OR6:
    s_waitcnt vmcnt(0)
    s_mov_b32 s89, 0
L_OR6S:
    buffer_load_dwordx4 v[52:55], v8, s[68:71], s100 offen sc1
    s_waitcnt vmcnt(0)
    v_max3_u32 v7, v52, v53, v54
    v_max_u32 v7, v7, v55
    v_cmp_eq_u32 vcc, -1, v7
    s_cbranch_vccz L_OR6D
    s_add_u32 s89, s89, 1
    s_cmp_lt_u32 s89, 20000
    s_cbranch_scc1 L_OR6S
L_OR6D:
    buffer_load_dwordx4 v[56:59], v8, s[68:71], s101 offen sc1
    buffer_load_dwordx4 v[60:63], v8, s[68:71], s31 offen sc1
    s_branch L_OR6B
L_OR7:
    s_waitcnt vmcnt(0)
    s_mov_b32 s89, 0
L_OR7S:
    buffer_load_dwordx4 v[56:59], v8, s[68:71], s101 offen sc1
    s_waitcnt vmcnt(0)
    v_max3_u32 v7, v56, v57, v58
    v_max_u32 v7, v7, v59
    v_cmp_eq_u32 vcc, -1, v7
    s_cbranch_vccz L_OR7D
    s_add_u32 s89, s89, 1
    s_cmp_lt_u32 s89, 20000
    s_cbranch_scc1 L_OR7S
L_OR7D:
    buffer_load_dwordx4 v[60:63], v8, s[68:71], s31 offen sc1
    s_branch L_OR7B
L_OR8:
    s_waitcnt vmcnt(0)
    s_mov_b32 s89, 0
L_OR8S:
    buffer_load_dwordx4 v[60:63], v8, s[68:71], s31 offen sc1
    s_waitcnt vmcnt(0)
    v_max3_u32 v7, v60, v61, v62
    v_max_u32 v7, v7, v63
    v_cmp_eq_u32 vcc, -1, v7
    s_cbranch_vccz L_OR8D
    s_add_u32 s89, s89, 1
    s_cmp_lt_u32 s89, 20000
    s_cbranch_scc1 L_OR8S
L_OR8D:
    s_branch L_OR8B
L_SLOW:
    s_mov_b32 s93, 0
    v_sub_f32 v12, 0, v12
    v_mov_b32 v14, 1.0
    v_cvt_pk_bf16_f32 v14, v12, v14
    s_add_u32 s90, s3, 1
    v_accvgpr_write_b32 a97, v14
    v_accvgpr_write_b32 a99, v14
    v_accvgpr_write_b32 a101, v14
    v_accvgpr_write_b32 a103, v14
    buffer_load_dword a96, v18, s[68:71], s95 offen offset:0 sc1
    buffer_load_dwordx4 a[64:67], v5, s[68:71], s96 offen offset:0 sc1
    buffer_load_dwordx4 a[68:71], v5, s[68:71], s96 offen offset:1024 sc1
    buffer_load_dword a98, v18, s[68:71], s95 offen offset:256 sc1
    buffer_load_dwordx4 a[0:3], v19, s[68:71], s98 offen offset:0 sc1
    buffer_load_dwordx4 a[4:7], v19, s[68:71], s98 offen offset:1024 sc1
    buffer_load_dwordx4 a[72:75], v5, s[68:71], s96 offen offset:2048 sc1
    buffer_load_dwordx4 a[76:79], v5, s[68:71], s96 offen offset:3072 sc1
    buffer_load_dwordx4 a[8:11], v19, s[68:71], s98 offen offset:2048 sc1
    buffer_load_dwordx4 a[12:15], v19, s[68:71], s98 offen offset:3072 sc1
    buffer_load_dword a100, v18, s[68:71], s95 offen offset:512 sc1
    buffer_load_dwordx4 a[16:19], v19, s[68:71], s99 offen offset:0 sc1
    buffer_load_dwordx4 a[20:23], v19, s[68:71], s99 offen offset:1024 sc1
    buffer_load_dwordx4 a[80:83], v5, s[68:71], s97 offen offset:0 sc1
    buffer_load_dwordx4 a[84:87], v5, s[68:71], s97 offen offset:1024 sc1
    buffer_load_dwordx4 a[24:27], v19, s[68:71], s99 offen offset:2048 sc1
    buffer_load_dwordx4 a[28:31], v19, s[68:71], s99 offen offset:3072 sc1
    buffer_load_dword a102, v18, s[68:71], s95 offen offset:768 sc1
    buffer_load_dwordx4 a[32:35], v19, s[68:71], s100 offen offset:0 sc1
    buffer_load_dwordx4 a[36:39], v19, s[68:71], s100 offen offset:1024 sc1
    buffer_load_dwordx4 a[88:91], v5, s[68:71], s97 offen offset:2048 sc1
    buffer_load_dwordx4 a[92:95], v5, s[68:71], s97 offen offset:3072 sc1
    buffer_load_dwordx4 a[40:43], v19, s[68:71], s100 offen offset:2048 sc1
    buffer_load_dwordx4 a[44:47], v19, s[68:71], s100 offen offset:3072 sc1
    buffer_load_dwordx4 a[48:51], v19, s[68:71], s101 offen offset:0 sc1
    buffer_load_dwordx4 a[52:55], v19, s[68:71], s101 offen offset:1024 sc1
    buffer_load_dwordx4 a[56:59], v19, s[68:71], s101 offen offset:2048 sc1
    buffer_load_dwordx4 a[60:63], v19, s[68:71], s101 offen offset:3072 sc1
L_SLZ:
    s_lshl_b32 s84, s76, 7
    v_and_b32 v41, 31, v0
    v_lshlrev_b32 v41, 2, v41
    v_add_u32 v44, 161024, v41
    v_add_u32 v31, s84, v44
    v_mov_b32 v40, 0
    ds_write_b32 v31, v40
    v_mov_b32 v42, v9
    v_mov_b32 v43, v10
    s_mov_b32 s85, 0
    s_waitcnt vmcnt(0) lgkmcnt(0)
    s_barrier
L_SL1:
    ds_read_b128 v[26:29], v42
    ds_read_b32 v24, v43
    v_mov_b32 v25, 0
    v_mov_b32 v40, 0xff800000
    s_waitcnt lgkmcnt(0)
    v_mfma_f32_32x32x4_2b_bf16 v[64:95], a[96:97], v[24:25], 0
    s_nop 15
    s_nop 1
    v_mfma_f32_32x32x16_bf16 v[64:79], a[64:67], v[26:29], v[64:79]
    v_mfma_f32_32x32x16_bf16 v[80:95], a[68:71], v[26:29], v[80:95]
    s_nop 10
    v_max3_f32 v40, v40, v64, v65
    v_max3_f32 v40, v40, v66, v67
    v_max3_f32 v40, v40, v68, v69
    v_max3_f32 v40, v40, v70, v71
    v_max3_f32 v40, v40, v72, v73
    v_max3_f32 v40, v40, v74, v75
    v_max3_f32 v40, v40, v76, v77
    v_max3_f32 v40, v40, v78, v79
    v_max3_f32 v40, v40, v80, v81
    v_max3_f32 v40, v40, v82, v83
    v_max3_f32 v40, v40, v84, v85
    v_max3_f32 v40, v40, v86, v87
    v_max3_f32 v40, v40, v88, v89
    v_max3_f32 v40, v40, v90, v91
    v_max3_f32 v40, v40, v92, v93
    v_max3_f32 v40, v40, v94, v95
    v_mfma_f32_32x32x4_2b_bf16 v[64:95], a[98:99], v[24:25], 0
    s_nop 15
    s_nop 1
    v_mfma_f32_32x32x16_bf16 v[64:79], a[72:75], v[26:29], v[64:79]
    v_mfma_f32_32x32x16_bf16 v[80:95], a[76:79], v[26:29], v[80:95]
    s_nop 10
    v_max3_f32 v40, v40, v64, v65
    v_max3_f32 v40, v40, v66, v67
    v_max3_f32 v40, v40, v68, v69
    v_max3_f32 v40, v40, v70, v71
    v_max3_f32 v40, v40, v72, v73
    v_max3_f32 v40, v40, v74, v75
    v_max3_f32 v40, v40, v76, v77
    v_max3_f32 v40, v40, v78, v79
    v_max3_f32 v40, v40, v80, v81
    v_max3_f32 v40, v40, v82, v83
    v_max3_f32 v40, v40, v84, v85
    v_max3_f32 v40, v40, v86, v87
    v_max3_f32 v40, v40, v88, v89
    v_max3_f32 v40, v40, v90, v91
    v_max3_f32 v40, v40, v92, v93
    v_max3_f32 v40, v40, v94, v95
    v_mfma_f32_32x32x4_2b_bf16 v[64:95], a[100:101], v[24:25], 0
    s_nop 15
    s_nop 1
    v_mfma_f32_32x32x16_bf16 v[64:79], a[80:83], v[26:29], v[64:79]
    v_mfma_f32_32x32x16_bf16 v[80:95], a[84:87], v[26:29], v[80:95]
    s_nop 10
    v_max3_f32 v40, v40, v64, v65
    v_max3_f32 v40, v40, v66, v67
    v_max3_f32 v40, v40, v68, v69
    v_max3_f32 v40, v40, v70, v71
    v_max3_f32 v40, v40, v72, v73
    v_max3_f32 v40, v40, v74, v75
    v_max3_f32 v40, v40, v76, v77
    v_max3_f32 v40, v40, v78, v79
    v_max3_f32 v40, v40, v80, v81
    v_max3_f32 v40, v40, v82, v83
    v_max3_f32 v40, v40, v84, v85
    v_max3_f32 v40, v40, v86, v87
    v_max3_f32 v40, v40, v88, v89
    v_max3_f32 v40, v40, v90, v91
    v_max3_f32 v40, v40, v92, v93
    v_max3_f32 v40, v40, v94, v95
    v_mfma_f32_32x32x4_2b_bf16 v[64:95], a[102:103], v[24:25], 0
    s_nop 15
    s_nop 1
    v_mfma_f32_32x32x16_bf16 v[64:79], a[88:91], v[26:29], v[64:79]
    v_mfma_f32_32x32x16_bf16 v[80:95], a[92:95], v[26:29], v[80:95]
    s_nop 10
    v_max3_f32 v40, v40, v64, v65
    v_max3_f32 v40, v40, v66, v67
    v_max3_f32 v40, v40, v68, v69
    v_max3_f32 v40, v40, v70, v71
    v_max3_f32 v40, v40, v72, v73
    v_max3_f32 v40, v40, v74, v75
    v_max3_f32 v40, v40, v76, v77
    v_max3_f32 v40, v40, v78, v79
    v_max3_f32 v40, v40, v80, v81
    v_max3_f32 v40, v40, v82, v83
    v_max3_f32 v40, v40, v84, v85
    v_max3_f32 v40, v40, v86, v87
    v_max3_f32 v40, v40, v88, v89
    v_max3_f32 v40, v40, v90, v91
    v_max3_f32 v40, v40, v92, v93
    v_max3_f32 v40, v40, v94, v95
    v_ashrrev_i32 v41, 31, v40
    v_or_b32 v41, 0x80000000, v41
    v_xor_b32 v41, v41, v40
    ds_max_u32 v44, v41
    v_add_u32 v44, 128, v44
    v_add_u32 v42, 1280, v42
    v_add_u32 v43, 1280, v43
    s_add_u32 s85, s85, 1
    s_cmp_lt_u32 s85, 8
    s_cbranch_scc1 L_SL1
    s_waitcnt lgkmcnt(0)
    s_barrier
    ds_read_b32 v41, v31
    v_lshlrev_b32 v44, 16, v14
    v_rcp_f32 v43, v44
    s_waitcnt lgkmcnt(0)
    v_ashrrev_i32 v40, 31, v41
    v_not_b32 v40, v40
    v_or_b32 v40, 0x80000000, v40
    v_xor_b32 v40, v40, v41
    v_mul_f32 v41, v40, v43
    v_sub_f32 v41, 0, v41
    v_cvt_pk_bf16_f32 v41, v41, v41
    v_lshlrev_b32 v41, 16, v41
    v_fma_f32 v42, -v41, v44, -v40
    v_cvt_pk_bf16_f32 v41, v41, v42
    s_mul_i32 s84, s76, 1280
    v_add_u32 v42, s84, v10
    ds_write_b32 v42, v41 offset:4
    s_waitcnt lgkmcnt(0)
    s_barrier
    s_mul_i32 s84, s3, 1280
    v_add_u32 v42, s84, v10
    ds_read_b64 v[24:25], v42
    v_mov_b32 v32, 0
    v_mov_b32 v33, 0
    v_mov_b32 v34, 0
    v_mov_b32 v35, 0
    v_mov_b32 v36, 0
    v_mov_b32 v37, 0
    v_mov_b32 v38, 0
    v_mov_b32 v39, 0
    v_mov_b32 v40, 0
    v_mov_b32 v41, 0
    v_mov_b32 v42, 0
    v_mov_b32 v43, 0
    v_mov_b32 v44, 0
    v_mov_b32 v45, 0
    v_mov_b32 v46, 0
    v_mov_b32 v47, 0
    s_branch L_MAIN
L_CODE_END:
.section .rodata,"a"
.p2align 6
.amdhsa_kernel sequential_preLN__grouped_kv_mqa__moe_arch_mod__prompt_kernel
  .amdhsa_next_free_vgpr 256
  .amdhsa_next_free_sgpr 102
  .amdhsa_accum_offset 128
  .amdhsa_group_segment_fixed_size 0
  .amdhsa_kernarg_size 104
  .amdhsa_user_sgpr_count 2
  .amdhsa_user_sgpr_kernarg_segment_ptr 1
  .amdhsa_system_sgpr_workgroup_id_x 1
.end_amdhsa_kernel
```
